```python
import torch

def _softmax(x, axis=-1):
    return torch.softmax(x, dim=axis)

def _gelu(x):
    return torch.nn.functional.gelu(x, approximate='tanh')

def _silu(x):
    return torch.nn.functional.silu(x)

def _sigmoid(x):
    return torch.sigmoid(x)

def _layernorm(x, axis=-1, eps=1e-05):
    m = x.mean(dim=axis, keepdim=True)
    v = x.var(dim=axis, keepdim=True, unbiased=False)
    return (x - m) / torch.sqrt(v + eps)

def _scatter_add(tgt, idx, src, axis=0):
    return tgt.clone().index_add_(axis, idx, src)

def _segment_sum(src, seg, n):
    out = torch.zeros((n,) + src.shape[1:], dtype=src.dtype)
    return out.index_add_(0, seg, src)

def _pad(x, pw):
    flat = tuple((v for pair in reversed(pw) for v in pair))
    return torch.nn.functional.pad(x, flat)
kernel_name = 'standalone__tensor_product_equiv_mace__graph'

def setup_inputs():

    _w = lambda a: (lambda t: t.to(torch.bfloat16) if t.is_floating_point() else t)(torch.as_tensor(a))
    N, deg = (25000, 32)
    Lmax, C, De = (1, 64, 16)
    M = (Lmax + 1) ** 2
    E = N * deg
    src = (lambda lo, hi, *s: torch.randint(lo, hi, s))(0, N, E).to(torch.int64)
    dst = (lambda lo, hi, *s: torch.randint(lo, hi, s))(0, N, E).to(torch.int64)
    r = (lambda *s: torch.randn(*s, dtype=torch.bfloat16) * 0.05)(E, 3).to(float)
    r = r / (torch.linalg.norm(r, dim=-1, keepdim=True).to(float) + 1e-06)
    rx, ry, rz = (r[:, 0].clone(), r[:, 1].clone(), r[:, 2].clone())
    x2, y2, z2 = (rx * rx, ry * ry, rz * rz)
    sh_list = [torch.ones_like(rx), rx, ry, rz, rx * ry, ry * rz, 2.0 * z2 - x2 - y2, rx * rz, x2 - y2, ry * (3.0 * x2 - y2), rx * ry * rz, ry * (4.0 * z2 - x2 - y2), rz * (2.0 * z2 - 3.0 * x2 - 3.0 * y2), rx * (4.0 * z2 - x2 - y2), rz * (x2 - y2), rx * (x2 - 3.0 * y2)]
    sh16 = torch.stack(sh_list, dim=-1).to(float)
    pad = max(0, M - 16)
    sh_full = torch.cat([sh16, torch.zeros((E, pad), dtype=float)], dim=-1)[:, :M]
    cg = ((lambda *s: torch.randn(*s, dtype=torch.bfloat16) * 0.05)(M, M, M) * (1.0 / float(M))).to(float)
    return {'x': _w(((lambda *s: torch.randn(*s, dtype=torch.bfloat16) * 0.05)(N, M, C) * 0.3).to(float)), 'src': _w(src), 'dst': _w(dst), 'sh': _w(sh_full.to(float)), 'edge_attr': _w(((lambda *s: torch.randn(*s, dtype=torch.bfloat16) * 0.05)(E, De) * 0.3).to(float)), 'cg': _w(cg), 'w_r': _w(((lambda *s: torch.randn(*s, dtype=torch.bfloat16) * 0.05)(De, C) * (1.0 / float(De) ** 0.5)).to(float)), 'w_out': _w(((lambda *s: torch.randn(*s, dtype=torch.bfloat16) * 0.05)(C, C) * (1.0 / float(C) ** 0.5)).to(float))}

def reference(x, src, dst, sh, edge_attr, cg, w_r, w_out):
    N = x.shape[0]
    M = x.shape[1]
    C = x.shape[2]
    h = x[src]
    tp = torch.einsum('uvw,euc,ev->ewc', cg, h, sh)
    rw = edge_attr @ w_r
    msg = tp * rw[:, None, :]
    msg2 = msg.reshape(-1, M * C)
    agg = _segment_sum(msg2, dst, N).reshape(N, M, C)
    out = torch.einsum('nmc,cd->nmd', agg, w_out)
    return out
```

```asm
; @launch grid=(256,1,1) block=(512,1,1) lds=163232
.amdgcn_target "amdgcn-amd-amdhsa--gfx950"
.text
.globl standalone__tensor_product_equiv_mace__graph_kernel
.p2align 8
.type standalone__tensor_product_equiv_mace__graph_kernel,@function
standalone__tensor_product_equiv_mace__graph_kernel:
    s_cmp_ge_u32 s2, 0x100
    s_cbranch_scc1 L2_end
    s_load_dwordx16 s[4:19], s[0:1], 0
    s_load_dwordx4 s[20:23], s[0:1], 64
    s_load_dwordx2 s[24:25], s[0:1], 80
    s_getpc_b64 s[90:91]
L_pc:
    v_lshlrev_b32 v234, 7, v0
    v_min_u32 v234, L2_end-L_pc, v234
    v_add_co_u32 v234, vcc, s90, v234
    v_mov_b32 v235, s91
    v_lshlrev_b32 v196, 2, v0
    v_addc_co_u32 v235, vcc, 0, v235, vcc
    global_load_dword v187, v[234:235], off
    s_and_b32 s26, s2, 7
    s_lshl_b32 s26, s26, 5
    s_lshr_b32 s3, s2, 3
    s_add_u32 s26, s26, s3
    s_mul_i32 s87, s26, 3136
    s_sub_u32 s88, 800000, s87
    s_min_u32 s88, s88, 3136
    s_lshl_b32 s90, s87, 2
    s_lshl_b32 s30, s88, 2
    s_mov_b32 s31, 0x20000
    s_waitcnt lgkmcnt(0)
    s_add_u32 s28, s8, s90
    s_addc_u32 s29, s9, 0
    buffer_load_dword v132, v196, s[28:31], 0 offen offset:0 nt
    buffer_load_dword v133, v196, s[28:31], 0 offen offset:2048 nt
    v_add_u32 v200, 4096, v196
    buffer_load_dword v134, v200, s[28:31], 0 offen offset:0 nt
    buffer_load_dword v135, v200, s[28:31], 0 offen offset:2048 nt
    v_add_u32 v201, 8192, v196
    buffer_load_dword v136, v201, s[28:31], 0 offen offset:0 nt
    buffer_load_dword v137, v201, s[28:31], 0 offen offset:2048 nt
    v_add_u32 v202, 12288, v196
    buffer_load_dword v138, v202, s[28:31], 0 offen offset:0 nt
    s_add_u32 s32, s6, s90
    s_addc_u32 s33, s7, 0
    s_mov_b32 s34, s30
    s_mov_b32 s35, 0x20000
    buffer_load_dword v139, v196, s[32:35], 0 offen offset:0 nt
    buffer_load_dword v140, v196, s[32:35], 0 offen offset:2048 nt
    buffer_load_dword v141, v200, s[32:35], 0 offen offset:0 nt
    buffer_load_dword v142, v200, s[32:35], 0 offen offset:2048 nt
    buffer_load_dword v143, v201, s[32:35], 0 offen offset:0 nt
    buffer_load_dword v144, v201, s[32:35], 0 offen offset:2048 nt
    buffer_load_dword v145, v202, s[32:35], 0 offen offset:0 nt
    v_add_u32 v197, 157216, v196
    v_mov_b32 v198, 0
    ds_write_b32 v197, v198
    v_lshrrev_b32 v199, 6, v0
    v_lshlrev_b32 v204, 3, v0
    v_readfirstlane_b32 s27, v199
    v_lshlrev_b32 v62, 4, v0
    v_and_b32 v167, 63, v0
    s_lshl_b32 s83, s27, 10
    s_add_u32 s52, s24, 0x5080000
    s_addc_u32 s53, s25, 0
    s_mov_b32 s54, 0x8000
    s_mov_b32 s55, 0x20000
    s_xor_b32 s0, s2, 255
    s_or_b32 s0, s0, s27
    s_cbranch_scc1 L1_noinit
    s_mov_b32 s36, s22
    s_mov_b32 s37, s23
    s_mov_b32 s38, 0x100
    s_mov_b32 s39, 0x20000
    v_lshlrev_b32 v205, 8, v0
    v_mov_b32 v208, 0
    v_mov_b32 v209, 0
    v_mov_b32 v210, 0
    v_mov_b32 v211, 0
    v_lshrrev_b32 v206, 3, v0
    v_lshl_add_u32 v206, v206, 7, v62
    buffer_store_dwordx4 v[208:211], v206, s[52:55], 0 offen offset:0 sc1
    buffer_store_dwordx4 v[208:211], v206, s[52:55], 0 offen offset:2048 sc1
    v_add_u32 v206, 4096, v206
    buffer_store_dwordx4 v[208:211], v206, s[52:55], 0 offen offset:0 sc1
    buffer_store_dwordx4 v[208:211], v206, s[52:55], 0 offen offset:2048 sc1
    v_add_u32 v206, 4096, v206
    buffer_store_dwordx4 v[208:211], v206, s[52:55], 0 offen offset:0 sc1
    buffer_store_dwordx4 v[208:211], v206, s[52:55], 0 offen offset:2048 sc1
    v_add_u32 v206, 4096, v206
    buffer_store_dwordx4 v[208:211], v206, s[52:55], 0 offen offset:0 sc1
    buffer_store_dwordx4 v[208:211], v206, s[52:55], 0 offen offset:2048 sc1
    v_add_u32 v206, 4096, v206
    buffer_store_dwordx4 v[208:211], v206, s[52:55], 0 offen offset:0 sc1
    buffer_store_dwordx4 v[208:211], v206, s[52:55], 0 offen offset:2048 sc1
    v_add_u32 v206, 4096, v206
    buffer_store_dwordx4 v[208:211], v206, s[52:55], 0 offen offset:0 sc1
    buffer_store_dwordx4 v[208:211], v206, s[52:55], 0 offen offset:2048 sc1
    v_add_u32 v206, 4096, v206
    buffer_store_dwordx4 v[208:211], v206, s[52:55], 0 offen offset:0 sc1
    buffer_store_dwordx4 v[208:211], v206, s[52:55], 0 offen offset:2048 sc1
    v_add_u32 v206, 4096, v206
    buffer_store_dwordx4 v[208:211], v206, s[52:55], 0 offen offset:0 sc1
    buffer_store_dwordx4 v[208:211], v206, s[52:55], 0 offen offset:2048 sc1
    v_add_u32 v206, 4096, v206
    v_mov_b32 v206, 1
    s_waitcnt vmcnt(0)
    buffer_store_dword v206, v205, s[36:39], 0 offen sc1
L1_noinit:
    s_waitcnt lgkmcnt(0)
    s_barrier
    s_lshl_b32 s90, s87, 3
    s_lshl_b32 s91, s88, 3
    s_add_u32 s36, s10, s90
    s_addc_u32 s37, s11, 0
    s_mov_b32 s38, s91
    s_mov_b32 s39, 0x20000
    buffer_load_dwordx2 v[146:147], v204, s[36:39], 0 offen nt
    v_add_u32 v204, 4096, v204
    buffer_load_dwordx2 v[148:149], v204, s[36:39], 0 offen nt
    v_add_u32 v204, 4096, v204
    buffer_load_dwordx2 v[150:151], v204, s[36:39], 0 offen nt
    v_add_u32 v204, 4096, v204
    buffer_load_dwordx2 v[152:153], v204, s[36:39], 0 offen nt
    v_add_u32 v204, 4096, v204
    buffer_load_dwordx2 v[154:155], v204, s[36:39], 0 offen nt
    v_add_u32 v204, 4096, v204
    buffer_load_dwordx2 v[156:157], v204, s[36:39], 0 offen nt
    v_add_u32 v204, 4096, v204
    buffer_load_dwordx2 v[158:159], v204, s[36:39], 0 offen nt
    s_mov_b32 s32, s18
    s_mov_b32 s33, s19
    s_mov_b32 s34, 0x2000
    s_mov_b32 s35, 0x20000
    buffer_load_dwordx4 v[168:171], v62, s[32:35], 0 offen
    s_mov_b32 s32, s16
    s_mov_b32 s33, s17
    s_mov_b32 s34, 0x800
    s_mov_b32 s35, 0x20000
    buffer_load_dwordx4 v[172:175], v62, s[32:35], 0 offen
    s_mov_b32 s32, s14
    s_mov_b32 s33, s15
    s_mov_b32 s34, 0x80
    s_mov_b32 s35, 0x20000
    buffer_load_dwordx4 v[176:179], v62, s[32:35], 0 offen
    s_lshl_b32 s90, s87, 5
    s_lshl_b32 s91, s88, 5
    s_add_u32 s40, s12, s90
    s_addc_u32 s41, s13, 0
    s_mov_b32 s42, s91
    s_mov_b32 s43, 0x20000
    s_add_u32 m0, s83, 0
    s_nop 0
    buffer_load_dwordx4 v62, s[40:43], 0 offen nt lds
    s_add_u32 m0, s83, 8192
    v_add_u32 v62, 8192, v62
    buffer_load_dwordx4 v62, s[40:43], 0 offen nt lds
    s_lshr_b32 s0, s2, 3
    s_add_u32 s0, s0, s2
    s_and_b32 s0, s0, 7
    s_and_b32 s1, s2, 0xf8
    s_or_b32 s0, s0, s1
    s_lshl_b32 s90, s0, 18
    s_add_u32 s44, s24, s90
    s_addc_u32 s45, s25, 0
    s_mov_b32 s46, 0x40000
    s_mov_b32 s47, 0x20000
    s_bfe_u32 s69, s2, 0x40003
    s_lshl_b32 s69, s69, 14
    s_mov_b32 s69, 0
    s_mul_i32 s90, s0, 38400
    s_add_u32 s28, s24, 0x4000000
    s_addc_u32 s29, s25, 0
    s_add_u32 s28, s28, s90
    s_addc_u32 s29, s29, 0
    s_mov_b32 s30, 0x0
    s_mov_b32 s31, 0x20000
    s_add_u32 s48, s24, 0x5000000
    s_addc_u32 s49, s25, 0
    s_mov_b32 s50, 0x80000
    s_mov_b32 s51, 0x20000
    s_mov_b32 s36, s22
    s_mov_b32 s37, s23
    s_mov_b32 s38, 0x100
    s_mov_b32 s39, 0x20000
    v_add_u32 v206, 0, v0
    v_cmp_gt_u32 s[6:7], s88, v206
    v_add_u32 v206, 512, v0
    v_cmp_gt_u32 s[8:9], s88, v206
    v_add_u32 v206, 1024, v0
    v_cmp_gt_u32 s[10:11], s88, v206
    v_add_u32 v206, 1536, v0
    v_cmp_gt_u32 s[12:13], s88, v206
    v_add_u32 v206, 2048, v0
    v_cmp_gt_u32 s[14:15], s88, v206
    v_add_u32 v206, 2560, v0
    v_cmp_gt_u32 s[16:17], s88, v206
    v_add_u32 v206, 3072, v0
    v_cmp_gt_u32 s[18:19], s88, v206
    v_mov_b32 v205, 1
    s_mov_b32 s90, 12288
    s_mov_b32 s91, -3136
    v_mov_b32 v208, 157216
    v_mov_b32 v209, 158240
    s_waitcnt vmcnt(12)
    v_mul_u32_u24 v160, 42800, v132
    v_lshrrev_b32 v206, 27, v160
    v_mad_i32_i24 v206, v206, s91, v139
    v_add_u32 v207, 25000, v206
    v_min_u32 v216, v206, v207
    v_cmp_le_u32 s[0:1], s90, v216
    v_lshrrev_b32 v160, 22, v160
    v_mul_u32_u24 v206, 98, v160
    v_sub_u32 v132, v132, v206
    v_cndmask_b32 v207, v208, v209, s[0:1]
    v_lshl_add_u32 v160, v160, 2, v207
    s_mov_b64 exec, s[6:7]
    ds_add_rtn_u32 v188, v160, v205
    s_mov_b64 exec, -1
    v_mul_u32_u24 v161, 42800, v133
    v_lshrrev_b32 v206, 27, v161
    v_mad_i32_i24 v206, v206, s91, v140
    v_add_u32 v207, 25000, v206
    v_min_u32 v217, v206, v207
    v_cmp_le_u32 s[0:1], s90, v217
    v_lshrrev_b32 v161, 22, v161
    v_mul_u32_u24 v206, 98, v161
    v_sub_u32 v133, v133, v206
    v_cndmask_b32 v207, v208, v209, s[0:1]
    v_lshl_add_u32 v161, v161, 2, v207
    s_mov_b64 exec, s[8:9]
    ds_add_rtn_u32 v189, v161, v205
    s_mov_b64 exec, -1
    v_mul_u32_u24 v162, 42800, v134
    v_lshrrev_b32 v206, 27, v162
    v_mad_i32_i24 v206, v206, s91, v141
    v_add_u32 v207, 25000, v206
    v_min_u32 v218, v206, v207
    v_cmp_le_u32 s[0:1], s90, v218
    v_lshrrev_b32 v162, 22, v162
    v_mul_u32_u24 v206, 98, v162
    v_sub_u32 v134, v134, v206
    v_cndmask_b32 v207, v208, v209, s[0:1]
    v_lshl_add_u32 v162, v162, 2, v207
    s_mov_b64 exec, s[10:11]
    ds_add_rtn_u32 v190, v162, v205
    s_mov_b64 exec, -1
    v_mul_u32_u24 v163, 42800, v135
    v_lshrrev_b32 v206, 27, v163
    v_mad_i32_i24 v206, v206, s91, v142
    v_add_u32 v207, 25000, v206
    v_min_u32 v219, v206, v207
    v_cmp_le_u32 s[0:1], s90, v219
    v_lshrrev_b32 v163, 22, v163
    v_mul_u32_u24 v206, 98, v163
    v_sub_u32 v135, v135, v206
    v_cndmask_b32 v207, v208, v209, s[0:1]
    v_lshl_add_u32 v163, v163, 2, v207
    s_mov_b64 exec, s[12:13]
    ds_add_rtn_u32 v191, v163, v205
    s_mov_b64 exec, -1
    v_mul_u32_u24 v164, 42800, v136
    v_lshrrev_b32 v206, 27, v164
    v_mad_i32_i24 v206, v206, s91, v143
    v_add_u32 v207, 25000, v206
    v_min_u32 v220, v206, v207
    v_cmp_le_u32 s[0:1], s90, v220
    v_lshrrev_b32 v164, 22, v164
    v_mul_u32_u24 v206, 98, v164
    v_sub_u32 v136, v136, v206
    v_cndmask_b32 v207, v208, v209, s[0:1]
    v_lshl_add_u32 v164, v164, 2, v207
    s_mov_b64 exec, s[14:15]
    ds_add_rtn_u32 v192, v164, v205
    s_mov_b64 exec, -1
    v_mul_u32_u24 v165, 42800, v137
    v_lshrrev_b32 v206, 27, v165
    v_mad_i32_i24 v206, v206, s91, v144
    v_add_u32 v207, 25000, v206
    v_min_u32 v221, v206, v207
    v_cmp_le_u32 s[0:1], s90, v221
    v_lshrrev_b32 v165, 22, v165
    v_mul_u32_u24 v206, 98, v165
    v_sub_u32 v137, v137, v206
    v_cndmask_b32 v207, v208, v209, s[0:1]
    v_lshl_add_u32 v165, v165, 2, v207
    s_mov_b64 exec, s[16:17]
    ds_add_rtn_u32 v193, v165, v205
    s_mov_b64 exec, -1
    v_mul_u32_u24 v166, 42800, v138
    v_lshrrev_b32 v206, 27, v166
    v_mad_i32_i24 v206, v206, s91, v145
    v_add_u32 v207, 25000, v206
    v_min_u32 v222, v206, v207
    v_cmp_le_u32 s[0:1], s90, v222
    v_lshrrev_b32 v166, 22, v166
    v_mul_u32_u24 v206, 98, v166
    v_sub_u32 v138, v138, v206
    v_cndmask_b32 v207, v208, v209, s[0:1]
    v_lshl_add_u32 v166, v166, 2, v207
    s_mov_b64 exec, s[18:19]
    ds_add_rtn_u32 v194, v166, v205
    s_mov_b64 exec, -1
    s_add_u32 m0, s83, 16384
    v_add_u32 v62, 8192, v62
    buffer_load_dwordx4 v62, s[40:43], 0 offen nt lds
    s_add_u32 m0, s83, 24576
    v_add_u32 v62, 8192, v62
    buffer_load_dwordx4 v62, s[40:43], 0 offen nt lds
    s_xor_b32 s0, s69, 229376
    s_and_b32 s0, s0, 229376
    s_add_u32 s0, s0, s83
    s_and_b32 s1, s27, 1
    s_mul_i32 s1, s1, 7168
    s_add_u32 s0, s0, s1
    s_add_u32 s32, s44, s0
    s_addc_u32 s33, s45, 0
    s_mov_b32 s34, 0x4080
    s_mov_b32 s35, 0x20000
    s_cmp_ge_u32 s27, 2
    s_cbranch_scc1 L1_noprb
    v_lshrrev_b32 v207, 3, v167
    v_mul_u32_u24 v207, 16256, v207
    v_lshl_add_u32 v207, v167, 4, v207
    buffer_store_dwordx4 v[132:135], v207, s[32:35], 0 offen sc1
    v_mov_b32 v206, -1
    v_mov_b32 v207, 163200
    ds_write2_b32 v207, v206, v206 offset0:0 offset1:1
L1_noprb:
    v_mul_u32_u24 v207, 5350, v132
    v_and_b32 v207, 0x70000, v207
    v_lshrrev_b32 v216, 10, v216
    v_lshl_or_b32 v207, v216, 19, v207
    v_lshlrev_b32 v207, 8, v207
    v_lshl_add_u32 v207, v132, 2, v207
    v_lshl_add_u32 v139, v139, 9, v207
    v_mul_u32_u24 v207, 5350, v133
    v_and_b32 v207, 0x70000, v207
    v_lshrrev_b32 v217, 10, v217
    v_lshl_or_b32 v207, v217, 19, v207
    v_lshlrev_b32 v207, 8, v207
    v_lshl_add_u32 v207, v133, 2, v207
    v_lshl_add_u32 v140, v140, 9, v207
    v_mul_u32_u24 v207, 5350, v134
    v_and_b32 v207, 0x70000, v207
    v_lshrrev_b32 v218, 10, v218
    v_lshl_or_b32 v207, v218, 19, v207
    v_lshlrev_b32 v207, 8, v207
    v_lshl_add_u32 v207, v134, 2, v207
    v_lshl_add_u32 v141, v141, 9, v207
    v_mul_u32_u24 v207, 5350, v135
    v_and_b32 v207, 0x70000, v207
    v_lshrrev_b32 v219, 10, v219
    v_lshl_or_b32 v207, v219, 19, v207
    v_lshlrev_b32 v207, 8, v207
    v_lshl_add_u32 v207, v135, 2, v207
    v_lshl_add_u32 v142, v142, 9, v207
    v_mul_u32_u24 v207, 5350, v136
    v_and_b32 v207, 0x70000, v207
    v_lshrrev_b32 v220, 10, v220
    v_lshl_or_b32 v207, v220, 19, v207
    v_lshlrev_b32 v207, 8, v207
    v_lshl_add_u32 v207, v136, 2, v207
    v_lshl_add_u32 v143, v143, 9, v207
    v_mul_u32_u24 v207, 5350, v137
    v_and_b32 v207, 0x70000, v207
    v_lshrrev_b32 v221, 10, v221
    v_lshl_or_b32 v207, v221, 19, v207
    v_lshlrev_b32 v207, 8, v207
    v_lshl_add_u32 v207, v137, 2, v207
    v_lshl_add_u32 v144, v144, 9, v207
    v_mul_u32_u24 v207, 5350, v138
    v_and_b32 v207, 0x70000, v207
    v_lshrrev_b32 v222, 10, v222
    v_lshl_or_b32 v207, v222, 19, v207
    v_lshlrev_b32 v207, 8, v207
    v_lshl_add_u32 v207, v138, 2, v207
    v_lshl_add_u32 v145, v145, 9, v207
    v_lshlrev_b32 v212, 4, v167
    v_add_u32 v212, 157216, v212
    s_waitcnt lgkmcnt(0)
    s_barrier
    ds_read_b128 v[224:227], v212
    ds_read_b128 v[228:231], v212 offset:1024
    s_waitcnt lgkmcnt(0)
    v_add_u32 v217, v224, v225
    v_add_u32 v218, v217, v226
    v_add_u32 v208, v218, v227
    v_add_u32 v221, v228, v229
    v_add_u32 v222, v221, v230
    v_add_u32 v209, v222, v231
    v_lshl_add_u32 v213, v209, 16, v208
    v_and_b32 v208, 7, v0
    v_cmp_eq_u32 s[0:1], 7, v208
    v_add_u32_dpp v214, v213, v213 quad_perm:[1,0,3,2] row_mask:0xf bank_mask:0xf
    s_nop 1
    v_add_u32_dpp v214, v214, v214 quad_perm:[2,3,0,1] row_mask:0xf bank_mask:0xf
    s_nop 1
    v_add_u32_dpp v214, v214, v214 row_half_mirror row_mask:0xf bank_mask:0xf
    v_sub_u32 v214, 0x40004000, v214
    v_and_b32 v214, 0x00030003, v214
    v_cndmask_b32 v214, 0, v214, s[0:1]
    v_add_u32 v213, v213, v214
    v_mov_b32 v214, v213
    s_nop 1
    v_add_u32_dpp v214, v214, v214 row_shr:1 row_mask:0xf bank_mask:0xf
    s_nop 1
    v_add_u32_dpp v214, v214, v214 row_shr:2 row_mask:0xf bank_mask:0xf
    s_nop 1
    v_add_u32_dpp v214, v214, v214 row_shr:4 row_mask:0xf bank_mask:0xf
    s_nop 1
    v_add_u32_dpp v214, v214, v214 row_shr:8 row_mask:0xf bank_mask:0xf
    s_nop 1
    v_add_u32_dpp v214, v214, v214 row_bcast:15 row_mask:0xa bank_mask:0xf
    s_nop 1
    v_add_u32_dpp v214, v214, v214 row_bcast:31 row_mask:0xc bank_mask:0xf
    v_sub_u32 v213, v214, v213
    v_readlane_b32 s0, v214, 63
    v_and_b32 v216, 0xffff, v213
    v_lshrrev_b32 v220, 16, v213
    s_lshr_b32 s71, s0, 16
    s_and_b32 s0, s0, 0xffff
    s_add_u32 s71, s71, s0
    s_mul_i32 s1, s71, 12
    s_add_u32 s1, s1, 127
    s_and_b32 s30, s1, -128
    v_add_u32 v220, s0, v220
    v_add_u32 v219, v216, v218
    v_add_u32 v218, v216, v217
    v_add_u32 v217, v216, v224
    ds_write_b128 v212, v[216:219] offset:2048
    v_add_u32 v223, v220, v222
    v_add_u32 v222, v220, v221
    v_add_u32 v221, v220, v228
    ds_write_b128 v212, v[220:223] offset:3072
    ds_read_b32 v240, v160 offset:2048
    ds_read_b32 v241, v161 offset:2048
    ds_read_b32 v242, v162 offset:2048
    ds_read_b32 v243, v163 offset:2048
    ds_read_b32 v244, v164 offset:2048
    ds_read_b32 v245, v165 offset:2048
    ds_read_b32 v246, v166 offset:2048
    v_add_u32 v207, 4294810080, v160
    v_lshrrev_b32 v207, 7, v207
    v_add_u32 v132, 0, v0
    v_lshl_or_b32 v132, v207, 12, v132
    v_add_u32 v207, 4294810080, v161
    v_lshrrev_b32 v207, 7, v207
    v_add_u32 v133, 512, v0
    v_lshl_or_b32 v133, v207, 12, v133
    v_add_u32 v207, 4294810080, v162
    v_lshrrev_b32 v207, 7, v207
    v_add_u32 v134, 1024, v0
    v_lshl_or_b32 v134, v207, 12, v134
    v_add_u32 v207, 4294810080, v163
    v_lshrrev_b32 v207, 7, v207
    v_add_u32 v135, 1536, v0
    v_lshl_or_b32 v135, v207, 12, v135
    v_add_u32 v207, 4294810080, v164
    v_lshrrev_b32 v207, 7, v207
    v_add_u32 v136, 2048, v0
    v_lshl_or_b32 v136, v207, 12, v136
    v_add_u32 v207, 4294810080, v165
    v_lshrrev_b32 v207, 7, v207
    v_add_u32 v137, 2560, v0
    v_lshl_or_b32 v137, v207, 12, v137
    v_add_u32 v207, 4294810080, v166
    v_lshrrev_b32 v207, 7, v207
    v_add_u32 v138, 3072, v0
    v_lshl_or_b32 v138, v207, 12, v138
    s_add_u32 m0, s83, 32768
    v_add_u32 v62, 8192, v62
    buffer_load_dwordx4 v62, s[40:43], 0 offen nt lds
    s_mov_b32 s90, 112640
    s_mov_b32 s91, 150848
    s_waitcnt vmcnt(8) lgkmcnt(0)
    v_add_u32 v188, v188, v240
    v_mad_u32_u24 v160, v188, 12, s90
    v_lshl_add_u32 v188, v188, 1, s91
    v_add_u32 v189, v189, v241
    v_mad_u32_u24 v161, v189, 12, s90
    v_lshl_add_u32 v189, v189, 1, s91
    v_add_u32 v190, v190, v242
    v_mad_u32_u24 v162, v190, 12, s90
    v_lshl_add_u32 v190, v190, 1, s91
    v_add_u32 v191, v191, v243
    v_mad_u32_u24 v163, v191, 12, s90
    v_lshl_add_u32 v191, v191, 1, s91
    v_add_u32 v192, v192, v244
    v_mad_u32_u24 v164, v192, 12, s90
    v_lshl_add_u32 v192, v192, 1, s91
    v_add_u32 v193, v193, v245
    v_mad_u32_u24 v165, v193, 12, s90
    v_lshl_add_u32 v193, v193, 1, s91
    v_add_u32 v194, v194, v246
    v_mad_u32_u24 v166, v194, 12, s90
    v_lshl_add_u32 v194, v194, 1, s91
    s_mov_b64 exec, s[6:7]
    ds_write_b16 v188, v132
    ds_write2_b32 v160, v146, v147 offset0:0 offset1:1
    ds_write_b32 v160, v139 offset:8
    s_mov_b64 exec, s[8:9]
    ds_write_b16 v189, v133
    ds_write2_b32 v161, v148, v149 offset0:0 offset1:1
    ds_write_b32 v161, v140 offset:8
    s_mov_b64 exec, s[10:11]
    ds_write_b16 v190, v134
    ds_write2_b32 v162, v150, v151 offset0:0 offset1:1
    ds_write_b32 v162, v141 offset:8
    s_mov_b64 exec, s[12:13]
    ds_write_b16 v191, v135
    ds_write2_b32 v163, v152, v153 offset0:0 offset1:1
    ds_write_b32 v163, v142 offset:8
    s_mov_b64 exec, s[14:15]
    ds_write_b16 v192, v136
    ds_write2_b32 v164, v154, v155 offset0:0 offset1:1
    ds_write_b32 v164, v143 offset:8
    s_mov_b64 exec, s[16:17]
    ds_write_b16 v193, v137
    ds_write2_b32 v165, v156, v157 offset0:0 offset1:1
    ds_write_b32 v165, v144 offset:8
    s_mov_b64 exec, s[18:19]
    ds_write_b16 v194, v138
    ds_write2_b32 v166, v158, v159 offset0:0 offset1:1
    ds_write_b32 v166, v145 offset:8
    s_mov_b64 exec, -1
    s_add_u32 m0, s83, 40960
    v_add_u32 v62, 8192, v62
    buffer_load_dwordx4 v62, s[40:43], 0 offen nt lds
    s_add_u32 m0, s83, 49152
    v_add_u32 v62, 8192, v62
    buffer_load_dwordx4 v62, s[40:43], 0 offen nt lds
    v_lshlrev_b32 v60, 4, v0
    v_add_u32 v206, 112640, v60
    v_and_b32 v204, 0x1fe, v0
    v_add_u32 v204, 150848, v204
    s_waitcnt lgkmcnt(0)
    s_barrier
    ds_read_b128 v[8:11], v206 offset:0
    ds_read_b128 v[12:15], v206 offset:8192
    ds_read_b128 v[16:19], v206 offset:16384
    ds_read_b128 v[20:23], v206 offset:24576
    ds_read_b128 v[24:27], v206 offset:32768
    s_waitcnt lgkmcnt(4)
    buffer_store_dwordx4 v[8:11], v60, s[28:31], 0 offen sc1
    v_add_u32 v60, 8192, v60
    s_waitcnt lgkmcnt(3)
    buffer_store_dwordx4 v[12:15], v60, s[28:31], 0 offen sc1
    v_add_u32 v60, 8192, v60
    s_waitcnt lgkmcnt(2)
    buffer_store_dwordx4 v[16:19], v60, s[28:31], 0 offen sc1
    v_add_u32 v60, 8192, v60
    s_waitcnt lgkmcnt(1)
    buffer_store_dwordx4 v[20:23], v60, s[28:31], 0 offen sc1
    v_add_u32 v60, 8192, v60
    s_waitcnt lgkmcnt(0)
    buffer_store_dwordx4 v[24:27], v60, s[28:31], 0 offen sc1
    ds_read_u16 v240, v204 offset:0
    ds_read_u16 v241, v204 offset:512
    ds_read_u16 v242, v204 offset:1024
    ds_read_u16 v243, v204 offset:1536
    ds_read_u16 v244, v204 offset:2048
    ds_read_u16 v245, v204 offset:2560
    ds_read_u16 v246, v204 offset:3072
    ds_read_u16 v247, v204 offset:3584
    ds_read_u16 v248, v204 offset:4096
    ds_read_u16 v249, v204 offset:4608
    ds_read_u16 v250, v204 offset:5120
    ds_read_u16 v251, v204 offset:5632
    ds_read_u16 v252, v204 offset:6144
    v_and_b32 v204, 0x1f8, v0
    v_add_u32 v204, 150848, v204
    s_waitcnt lgkmcnt(2)
    ds_read_u16 v132, v204 offset:0
    ds_read_u16 v133, v204 offset:512
    ds_read_u16 v134, v204 offset:1024
    ds_read_u16 v135, v204 offset:1536
    ds_read_u16 v136, v204 offset:2048
    ds_read_u16 v137, v204 offset:2560
    ds_read_u16 v138, v204 offset:3072
    ds_read_u16 v139, v204 offset:3584
    ds_read_u16 v140, v204 offset:4096
    ds_read_u16 v141, v204 offset:4608
    ds_read_u16 v142, v204 offset:5120
    ds_read_u16 v143, v204 offset:5632
    ds_read_u16 v144, v204 offset:6144
    s_cmp_lg_u32 s27, 7
    s_cbranch_scc1 L1_nooff
    s_lshl_b32 s0, s26, 5
    v_lshlrev_b32 v213, 13, v167
    v_add_u32 v213, s0, v213
    v_lshl_add_u32 v224, v224, 16, v216
    v_lshl_add_u32 v225, v225, 16, v217
    v_lshl_add_u32 v226, v226, 16, v218
    v_lshl_add_u32 v227, v227, 16, v219
    v_lshl_add_u32 v228, v228, 16, v220
    v_lshl_add_u32 v229, v229, 16, v221
    v_lshl_add_u32 v230, v230, 16, v222
    v_lshl_add_u32 v231, v231, 16, v223
    buffer_store_dwordx4 v[224:227], v213, s[48:51], 0 offen offset:0 sc1
    buffer_store_dwordx4 v[228:231], v213, s[48:51], 0 offen offset:16 sc1
L1_nooff:
    v_mov_b32 v66, 0
    s_cmp_lg_u32 s27, 0
    s_cbranch_scc1 L1_noflag
    buffer_load_dword v67, v66, s[36:39], 0 offen sc1
L1_noflag:
    s_cmp_ge_u32 s27, 2
    s_cbranch_scc1 L1_nowarm
    s_load_dword s70, s[32:33], 0x4000
L1_nowarm:
    s_add_u32 m0, s83, 57344
    v_add_u32 v62, 8192, v62
    buffer_load_dwordx4 v62, s[40:43], 0 offen nt lds
    s_add_u32 m0, s83, 65536
    v_add_u32 v62, 8192, v62
    buffer_load_dwordx4 v62, s[40:43], 0 offen nt lds
    v_and_b32 v205, 1, v0
    v_lshlrev_b32 v205, 4, v205
    s_waitcnt lgkmcnt(0)
    v_mov_b32 v207, 163200
    s_cmp_ge_u32 s27, 2
    s_cbranch_scc1 L1_voted
    s_memtime s[56:57]
    s_waitcnt lgkmcnt(0)
    s_load_dword s70, s[32:33], 0
    s_waitcnt lgkmcnt(0)
    s_memtime s[58:59]
    s_and_b32 s0, s27, 1
    v_lshl_add_u32 v209, s0, 2, v207
    s_waitcnt lgkmcnt(0)
    s_sub_u32 s60, s58, s56
    s_mov_b64 exec, 1
    v_mov_b32 v208, s60
    ds_min_u32 v209, v208
    s_mov_b64 exec, -1
L1_voted:
    s_waitcnt lgkmcnt(0)
    s_barrier
    v_and_b32 v240, 0xfff, v240
    v_lshl_add_u32 v240, v240, 5, v205
    v_lshrrev_b32 v132, 12, v132
    v_and_b32 v241, 0xfff, v241
    v_lshl_add_u32 v241, v241, 5, v205
    v_lshrrev_b32 v133, 12, v133
    v_and_b32 v242, 0xfff, v242
    v_lshl_add_u32 v242, v242, 5, v205
    v_lshrrev_b32 v134, 12, v134
    v_and_b32 v243, 0xfff, v243
    v_lshl_add_u32 v243, v243, 5, v205
    v_lshrrev_b32 v135, 12, v135
    v_and_b32 v244, 0xfff, v244
    v_lshl_add_u32 v244, v244, 5, v205
    v_lshrrev_b32 v136, 12, v136
    v_and_b32 v245, 0xfff, v245
    v_lshl_add_u32 v245, v245, 5, v205
    v_lshrrev_b32 v137, 12, v137
    v_and_b32 v246, 0xfff, v246
    v_lshl_add_u32 v246, v246, 5, v205
    v_lshrrev_b32 v138, 12, v138
    v_and_b32 v247, 0xfff, v247
    v_lshl_add_u32 v247, v247, 5, v205
    v_lshrrev_b32 v139, 12, v139
    v_and_b32 v248, 0xfff, v248
    v_lshl_add_u32 v248, v248, 5, v205
    v_lshrrev_b32 v140, 12, v140
    v_and_b32 v249, 0xfff, v249
    v_lshl_add_u32 v249, v249, 5, v205
    v_lshrrev_b32 v141, 12, v141
    v_and_b32 v250, 0xfff, v250
    v_lshl_add_u32 v250, v250, 5, v205
    v_lshrrev_b32 v142, 12, v142
    v_and_b32 v251, 0xfff, v251
    v_lshl_add_u32 v251, v251, 5, v205
    v_lshrrev_b32 v143, 12, v143
    v_and_b32 v252, 0xfff, v252
    v_lshl_add_u32 v252, v252, 5, v205
    v_lshrrev_b32 v144, 12, v144
    v_mov_b32 v200, 0x7fff
    v_mov_b32 v201, 0x7fff
    v_mov_b32 v202, 0x7fff
    v_mov_b32 v203, 0x7fff
    v_lshlrev_b32 v196, 4, v0
    v_add_u32 v196, 141760, v196
    ds_write_b128 v196, v[200:203]
    v_cmp_gt_u32 vcc, 398, v0
    s_and_b64 exec, exec, vcc
    ds_write_b128 v196, v[200:203] offset:8192
    s_mov_b64 exec, -1
    v_mov_b32 v204, 0x40404040
    v_cmp_gt_u32 vcc, 228, v0
    v_add_u32 v196, 14560, v196
    s_nop 0
    v_cndmask_b32 v204, 0, v204, vcc
    v_mov_b32 v205, v204
    v_mov_b32 v206, v204
    v_mov_b32 v207, v204
    v_cmp_gt_u32 vcc, 324, v0
    s_and_b64 exec, exec, vcc
    ds_write_b128 v196, v[204:207]
    s_mov_b64 exec, -1
    s_waitcnt vmcnt(14)
    v_lshrrev_b32 v208, 3, v0
    v_mul_u32_u24 v208, 144, v208
    v_and_b32 v199, 7, v0
    v_lshl_add_u32 v208, v199, 4, v208
    v_add_u32 v208, 126976, v208
    s_mov_b32 s0, 0x05040100
    s_mov_b32 s1, 0x07060302
    v_perm_b32 v200, v169, v168, s0
    v_perm_b32 v201, v171, v170, s0
    v_perm_b32 v202, v169, v168, s1
    v_perm_b32 v203, v171, v170, s1
    ds_write_b128 v208, v[200:203]
    v_cmp_gt_u32 vcc, 0x80, v0
    s_and_b64 exec, exec, vcc
    ds_write_b128 v208, v[172:175] offset:9216
    v_cmp_gt_u32 vcc, 8, v0
    s_and_b64 exec, exec, vcc
    ds_write_b128 v208, v[176:179] offset:11520
    s_mov_b64 exec, -1
    s_mov_b32 s63, 0xc35000
    s_mov_b32 s62, 3520
    s_mov_b32 s57, 0
    s_mov_b32 s89, 1
    v_and_b32 v197, 7, v0
    v_bfe_u32 v198, v0, 3, 5
    v_add_u32 v237, v197, v198
    v_and_b32 v237, 7, v237
    v_lshl_add_u32 v237, v198, 3, v237
    v_lshlrev_b32 v237, 12, v237
    v_lshl_add_u32 v197, v197, 5, v198
    s_lshr_b32 s0, s26, 2
    s_lshl_b32 s0, s0, 11
    s_and_b32 s1, s26, 3
    s_add_u32 s0, s0, s1
    s_lshl_b32 s0, s0, 2
    v_lshl_add_u32 v64, v197, 5, s0
    v_lshrrev_b32 v199, 8, v0
    v_lshl_add_u32 v64, v199, 4, v64
    v_mov_b32 v210, 0x80000000
    s_lshr_b32 s90, s26, 5
    s_mul_i32 s90, s90, 1605632
    s_and_b32 s91, s26, 31
    s_mul_i32 s0, s91, 50176
    s_add_u32 s0, s0, 0
    s_add_u32 s0, s0, s90
    v_sub_u32 v211, 511, v0
    v_cmp_gt_u32 vcc, 392, v211
    v_lshlrev_b32 v209, 7, v211
    v_add_u32 v234, s0, v209
    v_cndmask_b32 v234, v210, v234, vcc
    v_cmp_gt_u32 vcc, 0, v211
    s_mul_i32 s0, s91, 0
    s_add_u32 s0, s0, s90
    v_add_u32 v235, s0, v209
    v_cndmask_b32 v235, v210, v235, vcc
    s_waitcnt lgkmcnt(0)
    s_barrier
    v_bfe_u32 v196, v0, 5, 1
    v_bfe_u32 v197, v0, 2, 2
    v_lshl_add_u32 v196, v196, 3, v197
    v_mul_u32_u24 v196, 144, v196
    v_add_u32 v196, 126976, v196
    v_bfe_u32 v198, v0, 4, 1
    v_and_b32 v199, 3, v0
    v_lshl_add_u32 v200, v198, 5, v196
    v_lshl_add_u32 v200, v199, 3, v200
    v_lshl_add_u32 v201, v198, 6, v196
    v_lshl_add_u32 v201, v199, 4, v201
    v_lshlrev_b32 v197, 3, v197
    v_add_u32 v197, 138496, v197
    ds_read_b64_tr_b16 v[76:77], v200 offset:9216
    ds_read_b64_tr_b16 v[78:79], v200 offset:9792
    ds_read_b64_tr_b16 v[80:81], v200 offset:9280
    ds_read_b64_tr_b16 v[82:83], v200 offset:9856
    ds_read_b64_tr_b16 v[84:85], v197 offset:0
    ds_read_b64_tr_b16 v[86:87], v197 offset:32
    ds_read_b64_tr_b16 v[88:89], v197 offset:64
    ds_read_b64_tr_b16 v[90:91], v197 offset:96
    s_waitcnt lgkmcnt(4)
    ds_read_b64_tr_b16 v[100:101], v201 offset:0
    ds_read_b64_tr_b16 v[102:103], v201 offset:576
    ds_read_b64_tr_b16 v[104:105], v201 offset:2304
    ds_read_b64_tr_b16 v[106:107], v201 offset:2880
    ds_read_b64_tr_b16 v[108:109], v201 offset:4608
    ds_read_b64_tr_b16 v[110:111], v201 offset:5184
    ds_read_b64_tr_b16 v[112:113], v201 offset:6912
    ds_read_b64_tr_b16 v[114:115], v201 offset:7488
    s_waitcnt lgkmcnt(4)
    ds_read_b64_tr_b16 v[116:117], v201 offset:8
    ds_read_b64_tr_b16 v[118:119], v201 offset:584
    ds_read_b64_tr_b16 v[120:121], v201 offset:2312
    ds_read_b64_tr_b16 v[122:123], v201 offset:2888
    ds_read_b64_tr_b16 v[124:125], v201 offset:4616
    ds_read_b64_tr_b16 v[126:127], v201 offset:5192
    ds_read_b64_tr_b16 v[128:129], v201 offset:6920
    ds_read_b64_tr_b16 v[130:131], v201 offset:7496
    s_mov_b32 s64, 0x0f0f0f0f
    s_mov_b32 s65, 0x0f0f0f0f
    s_mov_b32 s66, 0xf0f0f0f0
    s_mov_b32 s67, 0xf0f0f0f0
    v_mov_b32 v92, 0
    v_mov_b32 v93, 0
    v_mov_b32 v94, 0
    v_mov_b32 v95, 0
    v_mov_b32 v96, 0
    v_mov_b32 v97, 0
    v_mov_b32 v98, 0
    v_mov_b32 v99, 0
    v_and_b32 v3, 31, v0
    v_lshlrev_b32 v3, 4, v3
    v_bfe_u32 v196, v0, 4, 1
    v_lshlrev_b32 v196, 6, v196
    v_xor_b32 v3, v196, v3
    v_bfe_u32 v196, v0, 4, 2
    v_and_b32 v199, 3, v0
    v_lshlrev_b32 v199, 3, v199
    v_lshl_add_u32 v196, v196, 5, v199
    v_bfe_u32 v199, v0, 3, 1
    v_lshlrev_b32 v199, 6, v199
    v_xor_b32 v196, v196, v199
    v_bfe_u32 v199, v0, 2, 2
    v_lshl_add_u32 v196, v199, 7, v196
    s_mul_i32 s3, s27, 6144
    s_add_u32 s3, s3, 112640
    s_add_u32 s72, s3, 0
    v_add_u32 v182, s72, v196
    s_add_u32 s73, s3, 2048
    v_add_u32 v183, s73, v196
    s_add_u32 s74, s3, 4096
    v_add_u32 v184, s74, v196
    v_mul_u32_u24 v180, 80, v167
    v_add_u32 v180, s3, v180
    v_bfe_u32 v196, v0, 5, 1
    v_bfe_u32 v199, v0, 2, 2
    v_lshl_add_u32 v181, v196, 3, v199
    v_mul_u32_u24 v181, 80, v181
    v_bfe_u32 v199, v0, 4, 1
    v_lshl_add_u32 v181, v199, 5, v181
    v_and_b32 v199, 3, v0
    v_lshl_add_u32 v181, v199, 3, v181
    v_add_u32 v181, s3, v181
    s_waitcnt vmcnt(2) lgkmcnt(0)
    s_barrier
    s_cmp_lg_u32 s27, 0
    s_cbranch_scc1 L1_arrived
    v_mov_b32 v207, 163200
    ds_read_b64 v[208:209], v207
    s_getreg_b32 s90, hwreg(HW_REG_XCC_ID, 2, 1)
    s_add_u32 s1, s2, 24
    s_lshl_b32 s70, s90, s1
    s_cmp_lt_u32 s2, 8
    s_cselect_b32 s70, s70, 0
    s_add_u32 s70, s70, 1
    s_lshr_b32 s1, s2, 6
    s_lshl_b32 s1, s1, 2
    s_add_u32 s1, s1, 8
    s_waitcnt lgkmcnt(0)
    v_cmp_lt_u32 vcc, v209, v208
    s_and_b32 s0, vcc_lo, 1
    s_xor_b32 s0, s0, s90
    s_bfe_u32 s90, s2, 0x10003
    s_xor_b32 s0, s0, s90
    s_lshl_b32 s0, s0, s1
    s_add_u32 s70, s70, s0
    s_mov_b32 s1, 0
L1_flag:
    v_readfirstlane_b32 s0, v67
    s_cmp_eq_u32 s0, 1
    s_cbranch_scc1 L1_flagok
    buffer_load_dword v67, v66, s[36:39], 0 offen sc1
    s_add_u32 s1, s1, 1
    s_waitcnt vmcnt(0)
    s_cmp_lt_u32 s1, 1048576
    s_cbranch_scc1 L1_flag
L1_flagok:
    s_bfe_u32 s0, s2, 0x30003
    s_lshl_b32 s0, s0, 8
    s_add_u32 s0, s0, 0
    v_lshl_add_u32 v186, v0, 11, s0
    v_mov_b32 v185, s70
    s_mov_b64 exec, 0xff
    buffer_atomic_add v185, v186, s[52:55], 0 offen sc1
    s_mov_b64 exec, -1
L1_arrived:
    s_add_u32 m0, s83, 73728
    v_add_u32 v62, 8192, v62
    buffer_load_dwordx4 v62, s[40:43], 0 offen nt lds
    s_add_u32 m0, s83, 81920
    v_add_u32 v62, 8192, v62
    buffer_load_dwordx4 v62, s[40:43], 0 offen nt lds
    s_add_u32 m0, s83, 90112
    v_add_u32 v62, 8192, v62
    buffer_load_dwordx4 v62, s[40:43], 0 offen nt lds
    s_add_u32 m0, s83, 98304
    v_add_u32 v62, 8192, v62
    buffer_load_dwordx4 v62, s[40:43], 0 offen nt lds
    s_add_u32 s28, s24, 0x4000000
    s_addc_u32 s29, s25, 0
    s_mov_b32 s30, 0xc00000
    s_mov_b32 s31, 0x20000
    s_mov_b32 s32, s24
    s_mov_b32 s33, s25
    s_mov_b32 s34, 0x4000000
    s_mov_b32 s35, 0x20000
    s_mov_b32 s40, s4
    s_mov_b32 s41, s5
    s_mov_b32 s42, 0xc35000
    s_mov_b32 s43, 0x20000
    s_cmp_lg_u32 s27, 0
    s_cbranch_scc1 L1_seenA
    s_waitcnt vmcnt(0)
    s_and_b32 s0, s2, 7
    s_lshl_b32 s0, s0, 11
    s_add_u32 s0, s0, 0
    v_and_b32 v186, 7, v0
    v_lshl_add_u32 v186, v186, 8, s0
    s_mov_b32 s1, 0
L_pollA:
    buffer_load_dword v185, v186, s[52:55], 0 offen sc1
L_pollwA:
    s_add_u32 s1, s1, 1
    s_waitcnt vmcnt(0)
    v_cmp_ne_u32_sdwa vcc, v185, 32 src0_sel:BYTE_0 src1_sel:DWORD
    s_cmp_eq_u64 vcc, 0
    s_cbranch_scc1 L_polledA
    s_sleep 8
    s_cmp_lt_u32 s1, 1048576
    s_cbranch_scc1 L_pollA
L_polledA:
    v_lshrrev_b32 v186, 3, v0
    v_lshl_add_u32 v186, v186, 2, 8
    v_readlane_b32 s0, v185, 0
    v_bfe_u32 v186, v185, v186, 4
    s_lshr_b32 s0, s0, 24
    s_nop 0
    v_add_u32_dpp v186, v186, v186 quad_perm:[1,0,3,2] row_mask:0xf bank_mask:0xf
    s_nop 1
    v_add_u32_dpp v186, v186, v186 quad_perm:[2,3,0,1] row_mask:0xf bank_mask:0xf
    v_cmp_lt_u32 vcc, 16, v186
    s_xor_b32 s1, vcc_lo, 0xaaaaaaaa
    v_mov_b32 v208, s0
    v_mov_b32 v209, s1
    v_mov_b32 v186, 163200
    ds_write_b64 v186, v[208:209]
L1_seenA:
    v_mov_b32 v186, 163200
    s_waitcnt vmcnt(0) lgkmcnt(0)
    s_barrier
    buffer_load_dword v212, v64, s[48:51], 0 offen sc1
    ds_read_b64 v[208:209], v186
    ds_read_b128 v[8:11], v240
    ds_read_b128 v[20:23], v243
    ds_read_b128 v[36:39], v247
    ds_read_b128 v[40:43], v248
    ds_read_b128 v[24:27], v244
    ds_read_b128 v[12:15], v241
    ds_read_b128 v[44:47], v249
    ds_read_b128 v[48:51], v250
    ds_read_b128 v[16:19], v242
    ds_read_b128 v[28:31], v245
    ds_read_b128 v[52:55], v251
    ds_read_b128 v[32:35], v246
    ds_read_b128 v[56:59], v252
    v_lshlrev_b32 v60, 4, v0
    v_lshrrev_b32 v196, 1, v0
    s_sub_u32 s71, s71, 3072
    v_cmp_gt_i32 s[90:91], s71, v196
    v_mov_b32 v196, 0x80000000
    s_lshr_b32 s1, s26, 5
    s_waitcnt lgkmcnt(13)
    v_readfirstlane_b32 s76, v208
    v_readfirstlane_b32 s68, v209
    s_lshr_b32 s0, s76, s1
    s_and_b32 s70, s0, 1
    s_mul_i32 s0, s70, 65280
    s_or_b32 s0, s0, s76
    s_lshr_b32 s1, s2, 3
    s_bitcmp1_b32 s68, s1
    s_cselect_b32 s1, 0xffff, 0
    s_xor_b32 s0, s0, s1
    v_bfe_u32 v132, s0, v132, 1
    v_lshl_add_u32 v132, v132, 13, v60
    s_xor_b32 s1, s69, 0
    v_add_u32 v132, s1, v132
    s_waitcnt lgkmcnt(12)
    buffer_store_dwordx4 v[8:11], v132, s[44:47], 0 offen sc1
    v_bfe_u32 v135, s0, v135, 1
    v_lshl_add_u32 v135, v135, 13, v60
    s_xor_b32 s1, s69, 49152
    v_add_u32 v135, s1, v135
    s_waitcnt lgkmcnt(11)
    buffer_store_dwordx4 v[20:23], v135, s[44:47], 0 offen sc1
    v_bfe_u32 v139, s0, v139, 1
    v_lshl_add_u32 v139, v139, 13, v60
    s_xor_b32 s1, s69, 114688
    v_add_u32 v139, s1, v139
    s_waitcnt lgkmcnt(10)
    buffer_store_dwordx4 v[36:39], v139, s[44:47], 0 offen sc1
    v_bfe_u32 v140, s0, v140, 1
    v_lshl_add_u32 v140, v140, 13, v60
    s_xor_b32 s1, s69, 131072
    v_add_u32 v140, s1, v140
    s_waitcnt lgkmcnt(9)
    buffer_store_dwordx4 v[40:43], v140, s[44:47], 0 offen sc1
    v_bfe_u32 v136, s0, v136, 1
    v_lshl_add_u32 v136, v136, 13, v60
    s_xor_b32 s1, s69, 65536
    v_add_u32 v136, s1, v136
    s_waitcnt lgkmcnt(8)
    buffer_store_dwordx4 v[24:27], v136, s[44:47], 0 offen sc1
    v_bfe_u32 v133, s0, v133, 1
    v_lshl_add_u32 v133, v133, 13, v60
    s_xor_b32 s1, s69, 16384
    v_add_u32 v133, s1, v133
    s_waitcnt lgkmcnt(7)
    buffer_store_dwordx4 v[12:15], v133, s[44:47], 0 offen sc1
    v_bfe_u32 v141, s0, v141, 1
    v_lshl_add_u32 v141, v141, 13, v60
    s_xor_b32 s1, s69, 147456
    v_add_u32 v141, s1, v141
    s_waitcnt lgkmcnt(6)
    buffer_store_dwordx4 v[44:47], v141, s[44:47], 0 offen sc1
    v_bfe_u32 v142, s0, v142, 1
    v_lshl_add_u32 v168, v142, 13, v60
    s_xor_b32 s1, s69, 163840
    v_add_u32 v168, s1, v168
    v_bfe_u32 v134, s0, v134, 1
    v_lshl_add_u32 v169, v134, 13, v60
    s_xor_b32 s1, s69, 32768
    v_add_u32 v169, s1, v169
    v_bfe_u32 v137, s0, v137, 1
    v_lshl_add_u32 v170, v137, 13, v60
    s_xor_b32 s1, s69, 81920
    v_add_u32 v170, s1, v170
    v_bfe_u32 v143, s0, v143, 1
    v_lshl_add_u32 v171, v143, 13, v60
    s_xor_b32 s1, s69, 180224
    v_add_u32 v171, s1, v171
    v_bfe_u32 v138, s0, v138, 1
    v_lshl_add_u32 v172, v138, 13, v60
    s_xor_b32 s1, s69, 98304
    v_add_u32 v172, s1, v172
    v_bfe_u32 v144, s0, v144, 1
    v_lshl_add_u32 v173, v144, 13, v60
    s_xor_b32 s1, s69, 196608
    v_add_u32 v173, s1, v173
    v_cndmask_b32 v173, v196, v173, s[90:91]
    v_and_b32 v196, 7, v0
    v_lshrrev_b32 v197, 8, v0
    v_lshl_add_u32 v196, v197, 3, v196
    s_mul_i32 s0, s70, 255
    s_lshl_b32 s1, s76, 8
    s_or_b32 s0, s0, s1
    v_bfe_u32 v196, s0, v196, 1
    v_lshrrev_b32 v197, 3, v0
    v_bfe_u32 v197, s68, v197, 1
    v_cmp_ne_u32 s[94:95], v196, v197
    s_waitcnt vmcnt(7)
    v_lshrrev_b32 v236, 16, v212
    v_and_b32 v212, 0xffff, v212
    v_mov_b32 v196, v236
    v_add_u32 v237, v237, v212
    v_lshl_or_b32 v2, v236, 20, v237
    s_nop 1
    v_add_u32_dpp v196, v196, v196 row_shr:1 row_mask:0xf bank_mask:0xf
    s_nop 1
    v_add_u32_dpp v196, v196, v196 row_shr:2 row_mask:0xf bank_mask:0xf
    s_nop 1
    v_add_u32_dpp v196, v196, v196 row_shr:4 row_mask:0xf bank_mask:0xf
    s_nop 1
    v_add_u32_dpp v196, v196, v196 row_shr:8 row_mask:0xf bank_mask:0xf
    s_nop 1
    v_add_u32_dpp v196, v196, v196 row_bcast:15 row_mask:0xa bank_mask:0xf
    s_nop 1
    v_add_u32_dpp v196, v196, v196 row_bcast:31 row_mask:0xc bank_mask:0xf
    s_lshl_b32 s0, s27, 2
    s_add_u32 s0, s0, 163168
    v_mov_b32 v197, s0
    v_sub_u32 v1, v196, v236
    s_mov_b32 exec_lo, 0
    s_brev_b32 exec_hi, 1
    ds_write_b32 v197, v196
    s_mov_b64 exec, -1
    v_and_b32 v197, 7, v0
    v_lshlrev_b32 v197, 2, v197
    v_add_u32 v197, 163168, v197
    s_waitcnt lgkmcnt(0)
    s_barrier
    ds_read_b32 v198, v197
    s_waitcnt lgkmcnt(0)
    v_mov_b32 v199, v198
    s_nop 1
    v_add_u32_dpp v199, v199, v199 row_shr:1 row_mask:0xf bank_mask:0xf
    s_nop 1
    v_add_u32_dpp v199, v199, v199 row_shr:2 row_mask:0xf bank_mask:0xf
    s_nop 1
    v_add_u32_dpp v199, v199, v199 row_shr:4 row_mask:0xf bank_mask:0xf
    v_sub_u32 v198, v199, v198
    v_readlane_b32 s56, v199, 7
    v_readlane_b32 s0, v198, s27
    v_readlane_b32 s79, v199, 3
    s_nop 0
    v_add_u32 v1, s0, v1
L2_round:
    s_sub_u32 s58, s56, s57
    s_min_u32 s58, s58, s62
    v_and_b32 v167, 63, v0
    v_lshrrev_b32 v236, 20, v2
    v_and_b32 v237, 0xfffff, v2
    v_or_b32 v197, 0x4000000, v237
    v_cndmask_b32 v237, v237, v197, s[94:95]
    v_sub_u32 v197, s57, v1
    v_max_i32 v198, 0, v197
    v_add_u32 v199, s62, v197
    v_min_i32 v199, v199, v236
    v_sub_u32 v200, v198, v197
    v_lshlrev_b32 v200, 2, v200
    v_add_u32 v200, 112640, v200
    v_add_u32 v201, v237, v198
    v_add_u32 v199, v237, v199
L2_exp:
    v_cmpx_lt_i32 vcc, v201, v199
    ds_write_b32 v200, v201 offset:0
    v_add_u32 v201, 1, v201
    v_cmpx_lt_i32 vcc, v201, v199
    ds_write_b32 v200, v201 offset:4
    v_add_u32 v201, 1, v201
    v_cmpx_lt_i32 vcc, v201, v199
    ds_write_b32 v200, v201 offset:8
    v_add_u32 v201, 1, v201
    v_cmpx_lt_i32 vcc, v201, v199
    ds_write_b32 v200, v201 offset:12
    v_add_u32 v201, 1, v201
    v_add_u32 v200, 16, v200
    s_cbranch_execnz L2_exp
    s_mov_b64 exec, -1
    v_lshlrev_b32 v196, 2, v0
    v_add_u32 v196, 112640, v196
    v_mov_b32 v198, 0x800000
    v_add_u32 v197, 0, v0
    v_cmp_gt_u32 s[6:7], s58, v197
    v_add_u32 v197, 512, v0
    v_cmp_gt_u32 s[8:9], s58, v197
    v_add_u32 v197, 1024, v0
    v_cmp_gt_u32 s[10:11], s58, v197
    v_add_u32 v197, 1536, v0
    v_cmp_gt_u32 s[12:13], s58, v197
    v_add_u32 v197, 2048, v0
    v_cmp_gt_u32 s[14:15], s58, v197
    v_add_u32 v197, 2560, v0
    v_cmp_gt_u32 s[16:17], s58, v197
    v_add_u32 v197, 3072, v0
    v_cmp_gt_u32 s[18:19], s58, v197
    s_not_b64 exec, s[6:7]
    s_cbranch_scc0 L2_nomark0
    ds_write_b32 v196, v198 offset:0
L2_nomark0:
    s_not_b64 exec, s[8:9]
    s_cbranch_scc0 L2_nomark1
    ds_write_b32 v196, v198 offset:2048
L2_nomark1:
    s_not_b64 exec, s[10:11]
    s_cbranch_scc0 L2_nomark2
    ds_write_b32 v196, v198 offset:4096
L2_nomark2:
    s_not_b64 exec, s[12:13]
    s_cbranch_scc0 L2_nomark3
    ds_write_b32 v196, v198 offset:6144
L2_nomark3:
    s_not_b64 exec, s[14:15]
    s_cbranch_scc0 L2_nomark4
    ds_write_b32 v196, v198 offset:8192
L2_nomark4:
    s_not_b64 exec, s[16:17]
    s_cbranch_scc0 L2_nomark5
    ds_write_b32 v196, v198 offset:10240
L2_nomark5:
    s_not_b64 exec, s[18:19]
    s_cbranch_scc0 L2_nomark6
    ds_write_b32 v196, v198 offset:12288
L2_nomark6:
    s_mov_b64 exec, -1
    v_lshrrev_b32 v199, 1, v0
    v_lshlrev_b32 v199, 2, v199
    v_add_u32 v199, 112640, v199
    v_and_b32 v200, 1, v0
    v_lshlrev_b32 v200, 4, v200
    s_waitcnt lgkmcnt(0)
    s_barrier
    s_mov_b32 s91, -10752
    ds_read_b32 v202, v196 offset:0
    ds_read_b32 v203, v196 offset:2048
    ds_read_b32 v204, v196 offset:4096
    ds_read_b32 v205, v196 offset:6144
    ds_read_b32 v206, v196 offset:8192
    ds_read_b32 v207, v196 offset:10240
    ds_read_b32 v208, v196 offset:12288
    ds_read2st64_b32 v[242:243], v199 offset0:0 offset1:4
    ds_read2st64_b32 v[244:245], v199 offset0:8 offset1:12
    ds_read2st64_b32 v[246:247], v199 offset0:16 offset1:20
    ds_read2st64_b32 v[248:249], v199 offset0:24 offset1:28
    ds_read2st64_b32 v[250:251], v199 offset0:32 offset1:36
    ds_read2st64_b32 v[252:253], v199 offset0:40 offset1:44
    ds_read2st64_b32 v[254:255], v199 offset0:48 offset1:52
    s_cmp_lg_u32 s89, 1
    s_cbranch_scc1 L2_non3
    buffer_store_dwordx4 v[48:51], v168, s[44:47], 0 offen sc1
    buffer_store_dwordx4 v[16:19], v169, s[44:47], 0 offen sc1
    buffer_store_dwordx4 v[28:31], v170, s[44:47], 0 offen sc1
    buffer_store_dwordx4 v[52:55], v171, s[44:47], 0 offen sc1
    buffer_store_dwordx4 v[32:35], v172, s[44:47], 0 offen sc1
    buffer_store_dwordx4 v[56:59], v173, s[44:47], 0 offen sc1
L2_non3:
    s_waitcnt lgkmcnt(13)
    v_mul_u32_u24 v197, 12, v202
    v_bfe_u32 v202, v202, 12, 8
    v_mad_i32_i24 v197, v202, s91, v197
    buffer_load_dwordx3 v[132:134], v197, s[28:31], 0 offen sc1
    s_waitcnt lgkmcnt(12)
    v_mul_u32_u24 v197, 12, v203
    v_bfe_u32 v203, v203, 12, 8
    v_mad_i32_i24 v197, v203, s91, v197
    buffer_load_dwordx3 v[136:138], v197, s[28:31], 0 offen sc1
    s_waitcnt lgkmcnt(11)
    v_mul_u32_u24 v197, 12, v204
    v_bfe_u32 v204, v204, 12, 8
    v_mad_i32_i24 v197, v204, s91, v197
    buffer_load_dwordx3 v[140:142], v197, s[28:31], 0 offen sc1
    s_waitcnt lgkmcnt(10)
    v_mul_u32_u24 v197, 12, v205
    v_bfe_u32 v205, v205, 12, 8
    v_mad_i32_i24 v197, v205, s91, v197
    buffer_load_dwordx3 v[144:146], v197, s[28:31], 0 offen sc1
    s_waitcnt lgkmcnt(9)
    v_mul_u32_u24 v197, 12, v206
    v_bfe_u32 v206, v206, 12, 8
    v_mad_i32_i24 v197, v206, s91, v197
    buffer_load_dwordx3 v[148:150], v197, s[28:31], 0 offen sc1
    s_waitcnt lgkmcnt(8)
    v_mul_u32_u24 v197, 12, v207
    v_bfe_u32 v207, v207, 12, 8
    v_mad_i32_i24 v197, v207, s91, v197
    buffer_load_dwordx3 v[152:154], v197, s[28:31], 0 offen sc1
    s_waitcnt lgkmcnt(7)
    v_mul_u32_u24 v197, 12, v208
    v_bfe_u32 v208, v208, 12, 8
    v_mad_i32_i24 v197, v208, s91, v197
    buffer_load_dwordx3 v[156:158], v197, s[28:31], 0 offen sc1
    v_mov_b32 v186, 0x80000000
    s_waitcnt vmcnt(7) lgkmcnt(0)
    s_barrier
    s_cmp_lg_u32 s89, 1
    s_cbranch_scc1 L2_arrivedB
    s_mov_b32 s89, 2
    s_cmp_lg_u32 s27, 0
    s_cbranch_scc1 L2_arrivedB
    s_bfe_u32 s0, s2, 0x30003
    s_lshl_b32 s0, s0, 8
    s_add_u32 s0, s0, 16384
    v_lshl_add_u32 v186, v0, 11, s0
    v_mov_b32 v185, 1
    s_mov_b64 exec, 0xff
    buffer_atomic_add v185, v186, s[52:55], 0 offen sc1
    s_mov_b64 exec, -1
L2_arrivedB:
    s_mov_b32 s90, 0x2000
    s_waitcnt lgkmcnt(0)
    v_lshrrev_b32 v197, 13, v242
    v_and_or_b32 v197, v197, s90, v200
    v_lshlrev_b32 v242, 5, v242
    v_and_b32 v198, 0xffffe000, v242
    v_add3_u32 v242, v242, v198, v197
    v_lshrrev_b32 v197, 13, v243
    v_and_or_b32 v197, v197, s90, v200
    v_lshlrev_b32 v243, 5, v243
    v_and_b32 v198, 0xffffe000, v243
    v_add3_u32 v243, v243, v198, v197
    v_lshrrev_b32 v197, 13, v244
    v_and_or_b32 v197, v197, s90, v200
    v_lshlrev_b32 v244, 5, v244
    v_and_b32 v198, 0xffffe000, v244
    v_add3_u32 v244, v244, v198, v197
    v_lshrrev_b32 v197, 13, v245
    v_and_or_b32 v197, v197, s90, v200
    v_lshlrev_b32 v245, 5, v245
    v_and_b32 v198, 0xffffe000, v245
    v_add3_u32 v245, v245, v198, v197
    v_lshrrev_b32 v197, 13, v246
    v_and_or_b32 v197, v197, s90, v200
    v_lshlrev_b32 v246, 5, v246
    v_and_b32 v198, 0xffffe000, v246
    v_add3_u32 v246, v246, v198, v197
    v_lshrrev_b32 v197, 13, v247
    v_and_or_b32 v197, v197, s90, v200
    v_lshlrev_b32 v247, 5, v247
    v_and_b32 v198, 0xffffe000, v247
    v_add3_u32 v247, v247, v198, v197
    v_lshrrev_b32 v197, 13, v248
    v_and_or_b32 v197, v197, s90, v200
    v_lshlrev_b32 v248, 5, v248
    v_and_b32 v198, 0xffffe000, v248
    v_add3_u32 v248, v248, v198, v197
    v_lshrrev_b32 v197, 13, v249
    v_and_or_b32 v197, v197, s90, v200
    v_lshlrev_b32 v249, 5, v249
    v_and_b32 v198, 0xffffe000, v249
    v_add3_u32 v249, v249, v198, v197
    v_lshrrev_b32 v197, 13, v250
    v_and_or_b32 v197, v197, s90, v200
    v_lshlrev_b32 v250, 5, v250
    v_and_b32 v198, 0xffffe000, v250
    v_add3_u32 v250, v250, v198, v197
    v_lshrrev_b32 v197, 13, v251
    v_and_or_b32 v197, v197, s90, v200
    v_lshlrev_b32 v251, 5, v251
    v_and_b32 v198, 0xffffe000, v251
    v_add3_u32 v251, v251, v198, v197
    v_lshrrev_b32 v197, 13, v252
    v_and_or_b32 v197, v197, s90, v200
    v_lshlrev_b32 v252, 5, v252
    v_and_b32 v198, 0xffffe000, v252
    v_add3_u32 v252, v252, v198, v197
    v_lshrrev_b32 v197, 13, v253
    v_and_or_b32 v197, v197, s90, v200
    v_lshlrev_b32 v253, 5, v253
    v_and_b32 v198, 0xffffe000, v253
    v_add3_u32 v253, v253, v198, v197
    v_lshrrev_b32 v197, 13, v254
    v_and_or_b32 v197, v197, s90, v200
    v_lshlrev_b32 v254, 5, v254
    v_and_b32 v198, 0xffffe000, v254
    v_add3_u32 v254, v254, v198, v197
    v_lshrrev_b32 v197, 13, v255
    v_and_or_b32 v197, v197, s90, v200
    v_lshlrev_b32 v255, 5, v255
    v_and_b32 v198, 0xffffe000, v255
    v_add3_u32 v255, v255, v198, v197
    s_cmp_eq_u32 s89, 0
    s_cbranch_scc1 L2_zeroed
    v_mov_b64 v[8:9], 0
    v_mov_b64 v[10:11], 0
    v_mov_b64 v[12:13], 0
    v_mov_b64 v[14:15], 0
    v_mov_b64 v[16:17], 0
    v_mov_b64 v[18:19], 0
    v_mov_b64 v[20:21], 0
    v_mov_b64 v[22:23], 0
    v_mov_b64 v[24:25], 0
    v_mov_b64 v[26:27], 0
    v_mov_b64 v[28:29], 0
    v_mov_b64 v[30:31], 0
    v_mov_b64 v[32:33], 0
    v_mov_b64 v[34:35], 0
    v_mov_b64 v[36:37], 0
    v_mov_b64 v[38:39], 0
    v_mov_b64 v[40:41], 0
    v_mov_b64 v[42:43], 0
    v_mov_b64 v[44:45], 0
    v_mov_b64 v[46:47], 0
    v_mov_b64 v[48:49], 0
    v_mov_b64 v[50:51], 0
    v_mov_b64 v[52:53], 0
    v_mov_b64 v[54:55], 0
    v_mov_b64 v[56:57], 0
    v_mov_b64 v[58:59], 0
    v_mov_b64 v[60:61], 0
    v_mov_b64 v[62:63], 0
    v_mov_b64 v[64:65], 0
    v_mov_b64 v[66:67], 0
    v_mov_b64 v[68:69], 0
    v_mov_b64 v[70:71], 0
    v_mov_b64 v[72:73], 0
    v_mov_b64 v[74:75], 0
L2_zeroed:
    s_add_u32 s0, s58, 1
    v_cvt_f32_u32 v196, s0
    v_rcp_f32 v196, v196
    v_mov_b32 v198, 1
    v_mul_f32 v196, 0x4b000000, v196
    v_cvt_u32_f32 v196, v196
    v_lshlrev_b32 v197, 3, v167
    v_readfirstlane_b32 s84, v196
    v_add_u32 v197, 160992, v197
    v_bfe_u32 v199, v0, 3, 1
    v_bfe_u32 v200, v0, 5, 1
    v_lshl_add_u32 v199, v199, 1, v200
    v_and_b32 v200, 7, v0
    v_add_u32 v224, -1, v200
    v_cmp_gt_u32 s[92:93], 4, v224
    v_lshl_add_u32 v199, v199, 3, v200
    v_lshlrev_b32 v220, 2, v199
    v_and_b32 v200, 3, v0
    v_lshrrev_b32 v199, 2, v167
    v_lshl_add_u32 v199, v200, 4, v199
    v_lshlrev_b32 v221, 3, v199
    v_lshlrev_b32 v222, 4, v167
    v_bfe_u32 v199, v0, 3, 2
    v_lshl_add_u32 v199, v199, 2, v200
    v_lshlrev_b32 v223, 2, v199
    v_lshlrev_b32 v196, 4, v167
    v_add_u32 v196, 159968, v196
    v_lshlrev_b32 v200, 17, v0
    s_mov_b32 s90, 159968
    s_waitcnt vmcnt(6)
    v_and_b32 v160, 0x1fc, v134
    v_add_u32 v160, 160992, v160
    s_mov_b64 exec, s[6:7]
    ds_add_rtn_u32 v188, v160, v198
    s_mov_b64 exec, -1
    v_bfe_u32 v199, v134, 9, 15
    v_or_b32 v135, v199, v200
    v_lshrrev_b32 v199, 27, v134
    v_lshl_add_u32 v226, v199, 2, s90
    v_and_b32 v134, 0x0700003c, v134
    v_add_u32 v200, 67108864, v200
    s_waitcnt vmcnt(5)
    v_and_b32 v161, 0x1fc, v138
    v_add_u32 v161, 160992, v161
    s_mov_b64 exec, s[8:9]
    ds_add_rtn_u32 v189, v161, v198
    s_mov_b64 exec, -1
    v_bfe_u32 v199, v138, 9, 15
    v_or_b32 v139, v199, v200
    v_lshrrev_b32 v199, 27, v138
    v_lshl_add_u32 v227, v199, 2, s90
    v_and_b32 v138, 0x0700003c, v138
    v_add_u32 v200, 67108864, v200
    s_waitcnt vmcnt(4)
    v_and_b32 v162, 0x1fc, v142
    v_add_u32 v162, 160992, v162
    s_mov_b64 exec, s[10:11]
    ds_add_rtn_u32 v190, v162, v198
    s_mov_b64 exec, -1
    v_bfe_u32 v199, v142, 9, 15
    v_or_b32 v143, v199, v200
    v_lshrrev_b32 v199, 27, v142
    v_lshl_add_u32 v228, v199, 2, s90
    v_and_b32 v142, 0x0700003c, v142
    v_add_u32 v200, 67108864, v200
    s_waitcnt vmcnt(3)
    v_and_b32 v163, 0x1fc, v146
    v_add_u32 v163, 160992, v163
    s_mov_b64 exec, s[12:13]
    ds_add_rtn_u32 v191, v163, v198
    s_mov_b64 exec, -1
    v_bfe_u32 v199, v146, 9, 15
    v_or_b32 v147, v199, v200
    v_lshrrev_b32 v199, 27, v146
    v_lshl_add_u32 v229, v199, 2, s90
    v_and_b32 v146, 0x0700003c, v146
    v_add_u32 v200, 67108864, v200
    s_waitcnt vmcnt(2)
    v_and_b32 v164, 0x1fc, v150
    v_add_u32 v164, 160992, v164
    s_mov_b64 exec, s[14:15]
    ds_add_rtn_u32 v192, v164, v198
    s_mov_b64 exec, -1
    v_bfe_u32 v199, v150, 9, 15
    v_or_b32 v151, v199, v200
    v_lshrrev_b32 v199, 27, v150
    v_lshl_add_u32 v230, v199, 2, s90
    v_and_b32 v150, 0x0700003c, v150
    v_add_u32 v200, 67108864, v200
    s_waitcnt vmcnt(1)
    v_and_b32 v165, 0x1fc, v154
    v_add_u32 v165, 160992, v165
    s_mov_b64 exec, s[16:17]
    ds_add_rtn_u32 v193, v165, v198
    s_mov_b64 exec, -1
    v_bfe_u32 v199, v154, 9, 15
    v_or_b32 v155, v199, v200
    v_lshrrev_b32 v199, 27, v154
    v_lshl_add_u32 v231, v199, 2, s90
    v_and_b32 v154, 0x0700003c, v154
    v_add_u32 v200, 67108864, v200
    s_waitcnt vmcnt(0)
    v_and_b32 v166, 0x1fc, v158
    v_add_u32 v166, 160992, v166
    s_mov_b64 exec, s[18:19]
    ds_add_rtn_u32 v194, v166, v198
    s_mov_b64 exec, -1
    v_bfe_u32 v199, v158, 9, 15
    v_or_b32 v159, v199, v200
    v_lshrrev_b32 v199, 27, v158
    v_lshl_add_u32 v232, v199, 2, s90
    v_and_b32 v158, 0x0700003c, v158
    s_waitcnt lgkmcnt(0)
    s_barrier
    ds_read_b64 v[200:201], v197
    s_cmp_eq_u32 s89, 0
    s_cbranch_scc1 L2_nopf234
    buffer_load_dword v187, v234, s[40:43], 0 offen
L2_nopf234:
    v_mul_u32_u24 v188, s84, v188
    v_mul_u32_u24 v189, s84, v189
    v_mul_u32_u24 v190, s84, v190
    v_mul_u32_u24 v191, s84, v191
    v_mul_u32_u24 v192, s84, v192
    v_mul_u32_u24 v193, s84, v193
    v_mul_u32_u24 v194, s84, v194
    s_waitcnt lgkmcnt(0)
    v_add_u32 v199, v200, v201
    v_mov_b32 v204, v199
    s_nop 1
    v_add_u32_dpp v204, v204, v204 row_shr:1 row_mask:0xf bank_mask:0xf
    s_nop 1
    v_add_u32_dpp v204, v204, v204 row_shr:2 row_mask:0xf bank_mask:0xf
    s_nop 1
    v_add_u32_dpp v204, v204, v204 row_shr:4 row_mask:0xf bank_mask:0xf
    s_nop 1
    v_add_u32_dpp v204, v204, v204 row_shr:8 row_mask:0xf bank_mask:0xf
    s_nop 1
    v_add_u32_dpp v204, v204, v204 row_bcast:15 row_mask:0xa bank_mask:0xf
    s_nop 1
    v_add_u32_dpp v204, v204, v204 row_bcast:31 row_mask:0xc bank_mask:0xf
    v_sub_u32 v202, v204, v199
    v_add_u32 v203, v202, v200
    v_mul_u32_u24 v202, s84, v202
    v_mul_u32_u24 v203, s84, v203
    v_mul_u32_u24 v204, s84, v204
    ds_write_b64 v197, v[202:203] offset:1536
    v_add_u32 v197, 1536, v197
    ds_read2_b32 v[206:207], v197 offset0:15 offset1:16
    ds_read_b32 v160, v160 offset:1536
    ds_read_b32 v161, v161 offset:1536
    ds_read_b32 v162, v162 offset:1536
    ds_read_b32 v163, v163 offset:1536
    ds_read_b32 v164, v164 offset:1536
    ds_read_b32 v165, v165 offset:1536
    ds_read_b32 v166, v166 offset:1536
    v_lshrrev_b32 v202, 20, v202
    v_lshrrev_b32 v203, 20, v203
    v_lshrrev_b32 v204, 20, v204
    v_sub_u32 v199, v203, v202
    v_sub_u32 v204, v204, v203
    v_max_u32 v199, v199, v204
    v_cmp_lt_u32 s[0:1], 1, v199
    v_readlane_b32 s59, v203, 48
    s_waitcnt lgkmcnt(7)
    v_lshrrev_b32 v206, 20, v206
    v_lshrrev_b32 v207, 20, v207
    v_cmp_ge_u32 vcc, v202, v206
    v_cmp_ge_u32 s[90:91], v203, v207
    s_and_b32 vcc_hi, vcc_hi, 0x3ff
    s_and_b32 s91, s91, 0x1ff
    s_or_b64 s[0:1], s[0:1], vcc
    s_or_b64 s[0:1], s[0:1], s[90:91]
    s_cbranch_scc1 L2_static
    s_cmp_lg_u32 s59, 7
    s_cbranch_scc1 L2_static
    s_cmp_lg_u32 s58, s56
    s_cbranch_scc1 L2_static
    s_waitcnt lgkmcnt(0)
    v_add_u32 v188, v188, v160
    v_lshrrev_b32 v188, 20, v188
    v_lshl_add_u32 v160, v188, 7, v226
    v_add_u32 v189, v189, v161
    v_lshrrev_b32 v189, 20, v189
    v_lshl_add_u32 v161, v189, 7, v227
    v_add_u32 v190, v190, v162
    v_lshrrev_b32 v190, 20, v190
    v_lshl_add_u32 v162, v190, 7, v228
    v_add_u32 v191, v191, v163
    v_lshrrev_b32 v191, 20, v191
    v_lshl_add_u32 v163, v191, 7, v229
    v_add_u32 v192, v192, v164
    v_lshrrev_b32 v192, 20, v192
    v_lshl_add_u32 v164, v192, 7, v230
    v_add_u32 v193, v193, v165
    v_lshrrev_b32 v193, 20, v193
    v_lshl_add_u32 v165, v193, 7, v231
    v_add_u32 v194, v194, v166
    v_lshrrev_b32 v194, 20, v194
    v_lshl_add_u32 v166, v194, 7, v232
    s_mov_b64 exec, s[6:7]
    ds_add_rtn_u32 v188, v160, v198
    s_mov_b64 exec, s[8:9]
    ds_add_rtn_u32 v189, v161, v198
    s_mov_b64 exec, s[10:11]
    ds_add_rtn_u32 v190, v162, v198
    s_mov_b64 exec, s[12:13]
    ds_add_rtn_u32 v191, v163, v198
    s_mov_b64 exec, s[14:15]
    ds_add_rtn_u32 v192, v164, v198
    s_mov_b64 exec, s[16:17]
    ds_add_rtn_u32 v193, v165, v198
    s_mov_b64 exec, s[18:19]
    ds_add_rtn_u32 v194, v166, v198
    s_mov_b64 exec, -1
    s_mov_b32 exec_hi, 0x1ffff
    v_cmp_gt_u32 vcc, s27, v202
    s_bcnt1_i32_b64 s85, vcc
    v_cmp_gt_u32 vcc, s27, v203
    s_bcnt1_i32_b64 s0, vcc
    s_add_u32 s85, s85, s0
    v_cmp_ge_u32 vcc, s27, v202
    s_bcnt1_i32_b64 s86, vcc
    v_cmp_ge_u32 vcc, s27, v203
    s_bcnt1_i32_b64 s0, vcc
    s_add_u32 s86, s86, s0
    s_mov_b64 exec, -1
    s_branch L2_cells
L2_static:
    s_mul_i32 s85, s27, 98
    s_add_u32 s86, s85, 105
    s_add_u32 s85, s85, 7
    s_lshr_b32 s85, s85, 3
    s_lshr_b32 s86, s86, 3
    s_waitcnt lgkmcnt(0)
    v_lshrrev_b32 v188, 24, v134
    v_lshl_add_u32 v160, v188, 7, v226
    v_lshrrev_b32 v189, 24, v138
    v_lshl_add_u32 v161, v189, 7, v227
    v_lshrrev_b32 v190, 24, v142
    v_lshl_add_u32 v162, v190, 7, v228
    v_lshrrev_b32 v191, 24, v146
    v_lshl_add_u32 v163, v191, 7, v229
    v_lshrrev_b32 v192, 24, v150
    v_lshl_add_u32 v164, v192, 7, v230
    v_lshrrev_b32 v193, 24, v154
    v_lshl_add_u32 v165, v193, 7, v231
    v_lshrrev_b32 v194, 24, v158
    v_lshl_add_u32 v166, v194, 7, v232
    s_mov_b64 exec, s[6:7]
    ds_add_rtn_u32 v188, v160, v198
    s_mov_b64 exec, s[8:9]
    ds_add_rtn_u32 v189, v161, v198
    s_mov_b64 exec, s[10:11]
    ds_add_rtn_u32 v190, v162, v198
    s_mov_b64 exec, s[12:13]
    ds_add_rtn_u32 v191, v163, v198
    s_mov_b64 exec, s[14:15]
    ds_add_rtn_u32 v192, v164, v198
    s_mov_b64 exec, s[16:17]
    ds_add_rtn_u32 v193, v165, v198
    s_mov_b64 exec, s[18:19]
    ds_add_rtn_u32 v194, v166, v198
    s_mov_b64 exec, -1
L2_cells:
    s_waitcnt lgkmcnt(0)
    s_barrier
    ds_read_b128 v[210:213], v196
    s_mov_b32 s90, 4294483776
    s_mov_b32 s91, 4293829376
    v_add_u32 v188, 156320, v188
    v_add_u32 v189, 156320, v189
    v_add_u32 v190, 156320, v190
    v_add_u32 v191, 156320, v191
    v_add_u32 v192, 156320, v192
    v_add_u32 v193, 156320, v193
    v_add_u32 v194, 156320, v194
    s_waitcnt lgkmcnt(0)
    v_add_u32 v215, v210, v211
    v_add_u32 v216, v215, v212
    v_add_u32 v197, v216, v213
    s_nop 1
    v_add_u32_dpp v198, v197, v197 quad_perm:[1,0,3,2] row_mask:0xf bank_mask:0xf
    s_nop 1
    v_add_u32_dpp v198, v198, v198 quad_perm:[2,3,0,1] row_mask:0xf bank_mask:0xf
    s_nop 1
    v_add_u32_dpp v198, v198, v198 row_half_mirror row_mask:0xf bank_mask:0xf
    v_add_u32 v199, 15, v198
    v_and_b32 v199, -16, v199
    v_sub_u32 v198, v199, v198
    v_add_u32 v198, v198, v224
    v_lshrrev_b32 v198, 2, v198
    v_cndmask_b32 v198, 0, v198, s[92:93]
    v_add_u32 v197, v197, v198
    v_mov_b32 v198, v197
    s_nop 1
    v_add_u32_dpp v198, v198, v198 row_shr:1 row_mask:0xf bank_mask:0xf
    s_nop 1
    v_add_u32_dpp v198, v198, v198 row_shr:2 row_mask:0xf bank_mask:0xf
    s_nop 1
    v_add_u32_dpp v198, v198, v198 row_shr:4 row_mask:0xf bank_mask:0xf
    s_nop 1
    v_add_u32_dpp v198, v198, v198 row_shr:8 row_mask:0xf bank_mask:0xf
    s_nop 1
    v_add_u32_dpp v198, v198, v198 row_bcast:15 row_mask:0xa bank_mask:0xf
    s_nop 1
    v_add_u32_dpp v198, v198, v198 row_bcast:31 row_mask:0xc bank_mask:0xf
    v_sub_u32 v214, v198, v197
    v_add_u32 v217, v214, v216
    v_add_u32 v216, v214, v215
    v_add_u32 v215, v214, v210
    ds_write_b128 v196, v[214:217] offset:1536
    ds_read_b32 v160, v160 offset:1536
    ds_read_b32 v161, v161 offset:1536
    ds_read_b32 v162, v162 offset:1536
    ds_read_b32 v163, v163 offset:1536
    ds_read_b32 v164, v164 offset:1536
    ds_read_b32 v165, v165 offset:1536
    ds_read_b32 v166, v166 offset:1536
    s_cmp_eq_u32 s89, 0
    s_cbranch_scc1 L2_nopre
    s_cmp_lg_u32 s27, 0
    s_cbranch_scc1 L2_nopre
    s_and_b32 s0, s2, 7
    s_lshl_b32 s0, s0, 11
    s_add_u32 s0, s0, 16384
    v_and_b32 v186, 7, v0
    v_lshl_add_u32 v186, v186, 8, s0
    buffer_load_dword v185, v186, s[52:55], 0 offen sc1
L2_nopre:
    v_sub_u32_dpp v201, v214, v214 row_shl:3 row_mask:0xf bank_mask:0xf
    s_lshl_b32 s0, s27, 3
    v_readlane_b32 s59, v199, s0
    v_readlane_b32 s61, v214, s0
    s_waitcnt lgkmcnt(6)
    v_add_u32 v188, v188, v160
    v_lshl_add_u32 v160, v188, 2, s90
    v_lshl_add_u32 v226, v188, 3, s91
    s_waitcnt lgkmcnt(5)
    v_add_u32 v189, v189, v161
    v_lshl_add_u32 v161, v189, 2, s90
    v_lshl_add_u32 v227, v189, 3, s91
    s_waitcnt lgkmcnt(4)
    v_add_u32 v190, v190, v162
    v_lshl_add_u32 v162, v190, 2, s90
    v_lshl_add_u32 v228, v190, 3, s91
    s_waitcnt lgkmcnt(3)
    v_add_u32 v191, v191, v163
    v_lshl_add_u32 v163, v191, 2, s90
    v_lshl_add_u32 v229, v191, 3, s91
    s_waitcnt lgkmcnt(2)
    v_add_u32 v192, v192, v164
    v_lshl_add_u32 v164, v192, 2, s90
    v_lshl_add_u32 v230, v192, 3, s91
    s_waitcnt lgkmcnt(1)
    v_add_u32 v193, v193, v165
    v_lshl_add_u32 v165, v193, 2, s90
    v_lshl_add_u32 v231, v193, 3, s91
    s_waitcnt lgkmcnt(0)
    v_add_u32 v194, v194, v166
    v_lshl_add_u32 v166, v194, 2, s90
    v_lshl_add_u32 v232, v194, 3, s91
    s_mov_b64 exec, s[6:7]
    ds_write_b32 v160, v135
    ds_write_b8 v188, v134
    ds_write_b64 v226, v[132:133]
    s_mov_b64 exec, s[8:9]
    ds_write_b32 v161, v139
    ds_write_b8 v189, v138
    ds_write_b64 v227, v[136:137]
    s_mov_b64 exec, s[10:11]
    ds_write_b32 v162, v143
    ds_write_b8 v190, v142
    ds_write_b64 v228, v[140:141]
    s_mov_b64 exec, s[12:13]
    ds_write_b32 v163, v147
    ds_write_b8 v191, v146
    ds_write_b64 v229, v[144:145]
    s_mov_b64 exec, s[14:15]
    ds_write_b32 v164, v151
    ds_write_b8 v192, v150
    ds_write_b64 v230, v[148:149]
    s_mov_b64 exec, s[16:17]
    ds_write_b32 v165, v155
    ds_write_b8 v193, v154
    ds_write_b64 v231, v[152:153]
    s_mov_b64 exec, s[18:19]
    ds_write_b32 v166, v159
    ds_write_b8 v194, v158
    ds_write_b64 v232, v[156:157]
    s_mov_b64 exec, -1
    v_max_u32_dpp v199, v199, v199 row_shl:8 row_mask:0xf bank_mask:0xf
    v_min_u32_dpp v201, v201, v201 row_shl:8 row_mask:0xf bank_mask:0xf
    s_lshr_b32 s59, s59, 4
    v_readlane_b32 s60, v199, 0
    v_readlane_b32 s82, v201, 0
    v_readlane_b32 s0, v199, 16
    v_readlane_b32 s1, v201, 16
    s_max_u32 s60, s60, s0
    s_min_u32 s82, s82, s1
    v_readlane_b32 s0, v199, 32
    v_readlane_b32 s1, v201, 32
    s_max_u32 s60, s60, s0
    s_min_u32 s82, s82, s1
    v_readlane_b32 s0, v199, 48
    v_readlane_b32 s1, v201, 48
    s_max_u32 s60, s60, s0
    s_min_u32 s82, s82, s1
    s_cmp_le_u32 s60, 512
    s_cbranch_scc1 L2_fits
    s_mov_b32 s62, 496
    s_waitcnt vmcnt(0) lgkmcnt(0)
    s_branch L2_again
L2_fits:
    s_lshl_b32 s0, s61, 2
    s_add_u32 s0, s0, 141760
    v_add_u32 v196, s0, v220
    v_add_u32 v201, s0, v223
    s_lshl_b32 s0, s61, 3
    s_add_u32 s0, s0, 112640
    v_add_u32 v199, s0, v221
    s_add_u32 s0, s61, 156320
    v_add_u32 v200, s0, v222
    v_add_u32 v202, 1024, v196
    v_add_u32 v203, 1024, v201
    s_cmp_eq_u32 s89, 0
    s_cbranch_scc1 L_polledB
    s_cmp_lg_u32 s27, 0
    s_cbranch_scc1 L_polledB
    s_mov_b32 s1, 0
    s_branch L_pollwB
L_pollB:
    buffer_load_dword v185, v186, s[52:55], 0 offen sc1
L_pollwB:
    s_add_u32 s1, s1, 1
    s_waitcnt vmcnt(0)
    v_cmp_ne_u32_sdwa vcc, v185, 32 src0_sel:BYTE_0 src1_sel:DWORD
    s_cmp_eq_u64 vcc, 0
    s_cbranch_scc1 L_polledB
    s_sleep 8
    s_cmp_lt_u32 s1, 1048576
    s_cbranch_scc1 L_pollB
L_polledB:
    s_waitcnt lgkmcnt(0)
    s_barrier
    s_add_u32 m0, s83, 0
    s_nop 0
    buffer_load_dwordx4 v242, s[32:35], 0 offen sc1 lds
    s_add_u32 m0, s83, 8192
    s_nop 0
    buffer_load_dwordx4 v243, s[32:35], 0 offen sc1 lds
    s_add_u32 m0, s83, 16384
    s_nop 0
    buffer_load_dwordx4 v244, s[32:35], 0 offen sc1 lds
    s_add_u32 m0, s83, 24576
    s_nop 0
    buffer_load_dwordx4 v245, s[32:35], 0 offen sc1 lds
    s_add_u32 m0, s83, 32768
    s_nop 0
    buffer_load_dwordx4 v246, s[32:35], 0 offen sc1 lds
    s_add_u32 m0, s83, 40960
    s_nop 0
    buffer_load_dwordx4 v247, s[32:35], 0 offen sc1 lds
    ds_read2_b32 v[132:133], v196 offset0:0 offset1:32
    ds_read2_b32 v[134:135], v196 offset0:64 offset1:96
    ds_read2_b32 v[136:137], v196 offset0:128 offset1:160
    ds_read2_b32 v[138:139], v196 offset0:192 offset1:224
    ds_read2_b32 v[140:141], v202 offset0:0 offset1:32
    ds_read2_b32 v[142:143], v202 offset0:64 offset1:96
    ds_read2_b32 v[144:145], v202 offset0:128 offset1:160
    ds_read2_b32 v[146:147], v202 offset0:192 offset1:224
    ds_read_b128 v[236:239], v200
    ds_read2_b32 v[204:205], v201 offset0:0 offset1:16
    ds_read2_b32 v[206:207], v201 offset0:32 offset1:48
    ds_read2_b32 v[208:209], v201 offset0:64 offset1:80
    ds_read2_b32 v[210:211], v201 offset0:96 offset1:112
    s_waitcnt lgkmcnt(7)
    ds_read2_b32 v[212:213], v201 offset0:128 offset1:144
    ds_read2_b32 v[214:215], v201 offset0:160 offset1:176
    ds_read2_b32 v[216:217], v201 offset0:192 offset1:208
    ds_read2_b32 v[218:219], v201 offset0:224 offset1:240
    ds_read2_b32 v[220:221], v203 offset0:0 offset1:16
    ds_read2_b32 v[222:223], v203 offset0:32 offset1:48
    s_waitcnt lgkmcnt(7)
    ds_read2_b32 v[224:225], v203 offset0:64 offset1:80
    ds_read2_b32 v[226:227], v203 offset0:96 offset1:112
    ds_read2_b32 v[228:229], v203 offset0:128 offset1:144
    ds_read2_b32 v[230:231], v203 offset0:160 offset1:176
    ds_read2_b32 v[232:233], v203 offset0:192 offset1:208
    ds_read2_b32 v[234:235], v203 offset0:224 offset1:240
    s_waitcnt lgkmcnt(6)
    ds_read_b64 v[148:149], v199 offset:0
    ds_read_b64 v[150:151], v199 offset:512
    ds_read_b64 v[152:153], v199 offset:1024
    ds_read_b64 v[154:155], v199 offset:1536
    ds_read_b64 v[156:157], v199 offset:2048
    ds_read_b64 v[158:159], v199 offset:2560
    ds_read_b64 v[160:161], v199 offset:3072
    ds_read_b64 v[162:163], v199 offset:3584
    s_sub_i32 s0, s79, s57
    s_max_i32 s0, s0, 0
    s_add_u32 s0, s0, 255
    s_lshr_b32 s0, s0, 8
    s_max_u32 s0, s0, 6
    s_add_u32 s1, s58, 255
    s_lshr_b32 s1, s1, 8
    s_lshr_b32 s82, s82, 4
    s_sub_i32 s82, s82, 1
    s_sub_i32 s1, s1, s0
    s_sub_i32 s90, s82, 1
    s_mul_i32 s90, s90, 1
    s_cmp_le_i32 s1, s90
    s_cselect_b32 s80, s0, 14
    s_cselect_b32 s82, s82, -1
    s_cmp_gt_i32 s1, 0
    s_cselect_b32 s82, s82, -1
    s_lshl_b32 s0, s27, 5
    s_sub_i32 s81, s58, s0
    s_add_i32 s81, s81, 255
    s_lshr_b32 s81, s81, 8
    s_mov_b32 s0, 6
    s_min_u32 s1, s80, s81
L2_early:
    s_cmp_ge_u32 s0, s1
    s_cbranch_scc1 L2_early_done
    s_set_gpr_idx_on s0, gpr_idx(SRC0)
    v_mov_b32 v186, v242
    s_set_gpr_idx_off
    s_lshl_b32 m0, s0, 13
    s_add_u32 m0, m0, s83
    s_add_u32 s0, s0, 1
    buffer_load_dwordx4 v186, s[32:35], 0 offen sc1 lds
    s_branch L2_early
L2_early_done:
    v_lshlrev_b32_sdwa v132, 9, v132 dst_sel:DWORD dst_unused:UNUSED_PAD src0_sel:DWORD src1_sel:WORD_0
    v_lshlrev_b32_sdwa v133, 9, v133 dst_sel:DWORD dst_unused:UNUSED_PAD src0_sel:DWORD src1_sel:WORD_0
    v_lshlrev_b32_sdwa v134, 9, v134 dst_sel:DWORD dst_unused:UNUSED_PAD src0_sel:DWORD src1_sel:WORD_0
    v_lshlrev_b32_sdwa v135, 9, v135 dst_sel:DWORD dst_unused:UNUSED_PAD src0_sel:DWORD src1_sel:WORD_0
    v_lshlrev_b32_sdwa v136, 9, v136 dst_sel:DWORD dst_unused:UNUSED_PAD src0_sel:DWORD src1_sel:WORD_0
    v_lshlrev_b32_sdwa v137, 9, v137 dst_sel:DWORD dst_unused:UNUSED_PAD src0_sel:DWORD src1_sel:WORD_0
    v_lshlrev_b32_sdwa v138, 9, v138 dst_sel:DWORD dst_unused:UNUSED_PAD src0_sel:DWORD src1_sel:WORD_0
    v_lshlrev_b32_sdwa v139, 9, v139 dst_sel:DWORD dst_unused:UNUSED_PAD src0_sel:DWORD src1_sel:WORD_0
    v_lshlrev_b32_sdwa v140, 9, v140 dst_sel:DWORD dst_unused:UNUSED_PAD src0_sel:DWORD src1_sel:WORD_0
    v_lshlrev_b32_sdwa v141, 9, v141 dst_sel:DWORD dst_unused:UNUSED_PAD src0_sel:DWORD src1_sel:WORD_0
    v_lshlrev_b32_sdwa v142, 9, v142 dst_sel:DWORD dst_unused:UNUSED_PAD src0_sel:DWORD src1_sel:WORD_0
    v_lshlrev_b32_sdwa v143, 9, v143 dst_sel:DWORD dst_unused:UNUSED_PAD src0_sel:DWORD src1_sel:WORD_0
    v_lshlrev_b32_sdwa v144, 9, v144 dst_sel:DWORD dst_unused:UNUSED_PAD src0_sel:DWORD src1_sel:WORD_0
    v_lshlrev_b32_sdwa v145, 9, v145 dst_sel:DWORD dst_unused:UNUSED_PAD src0_sel:DWORD src1_sel:WORD_0
    v_lshlrev_b32_sdwa v146, 9, v146 dst_sel:DWORD dst_unused:UNUSED_PAD src0_sel:DWORD src1_sel:WORD_0
    v_lshlrev_b32_sdwa v147, 9, v147 dst_sel:DWORD dst_unused:UNUSED_PAD src0_sel:DWORD src1_sel:WORD_0
    s_lshr_b32 s0, s59, 1
    s_bitcmp1_b32 s59, 0
    s_cselect_b32 exec_lo, 0xff00ff00, -1
    s_cmp_lt_u32 s59, 32
    s_cselect_b32 exec_lo, exec_lo, 0
    s_mov_b32 exec_hi, exec_lo
    s_set_gpr_idx_on s0, gpr_idx(DST)
    v_mov_b32 v132, 0xfffe00
    s_set_gpr_idx_off
    s_mov_b64 exec, -1
    v_mov_b32 v4, v132
    s_waitcnt lgkmcnt(0)
    s_mov_b32 s0, 0x07060302
    v_perm_b32 v164, v205, v204, s0
    v_perm_b32 v165, v207, v206, s0
    v_perm_b32 v166, v209, v208, s0
    v_perm_b32 v167, v211, v210, s0
    v_perm_b32 v168, v213, v212, s0
    v_perm_b32 v169, v215, v214, s0
    v_perm_b32 v170, v217, v216, s0
    v_perm_b32 v171, v219, v218, s0
    v_perm_b32 v172, v221, v220, s0
    v_perm_b32 v173, v223, v222, s0
    v_perm_b32 v174, v225, v224, s0
    v_perm_b32 v175, v227, v226, s0
    v_perm_b32 v176, v229, v228, s0
    v_perm_b32 v177, v231, v230, s0
    v_perm_b32 v178, v233, v232, s0
    v_perm_b32 v179, v235, v234, s0
    v_bfe_u32 v5, v0, 5, 1
    v_mul_u32_u24 v5, 0x10001, v5
    v_or_b32 v164, v164, v5
    v_or_b32 v165, v165, v5
    v_or_b32 v166, v166, v5
    v_or_b32 v167, v167, v5
    v_or_b32 v168, v168, v5
    v_or_b32 v169, v169, v5
    v_or_b32 v170, v170, v5
    v_or_b32 v171, v171, v5
    v_or_b32 v172, v172, v5
    v_or_b32 v173, v173, v5
    v_or_b32 v174, v174, v5
    v_or_b32 v175, v175, v5
    v_or_b32 v176, v176, v5
    v_or_b32 v177, v177, v5
    v_or_b32 v178, v178, v5
    v_or_b32 v179, v179, v5
    v_mfma_f32_4x4x4_16b_bf16 v[196:199], v[148:149], v[84:85], 0
    v_mfma_f32_4x4x4_16b_bf16 v[200:203], v[148:149], v[86:87], 0
    v_mfma_f32_4x4x4_16b_bf16 v[204:207], v[148:149], v[88:89], 0
    v_mfma_f32_4x4x4_16b_bf16 v[208:211], v[148:149], v[90:91], 0
    v_mov_b32 v5, v164
    v_readlane_b32 s68, v236, 0
    v_readlane_b32 s69, v238, 0
    s_mov_b32 s70, 16448
    s_mov_b32 s71, 16448
    s_mov_b32 s61, 0
    s_mov_b32 s77, 0
    v_cvt_pk_bf16_f32 v228, v196, v200
    v_cvt_pk_bf16_f32 v229, v204, v208
    v_cvt_pk_bf16_f32 v232, v197, v201
    v_cvt_pk_bf16_f32 v233, v205, v209
    s_waitcnt lgkmcnt(0)
    s_barrier
    s_mov_b32 s89, 0
    s_add_u32 m0, s72, 0
    v_add_u32_dpp v185, v4, v3 row_newbcast:0 row_mask:0xf bank_mask:0xf
    buffer_load_dwordx4 v185, s[40:43], 0 offen lds
    s_add_u32 m0, s72, 1024
    v_add_u32_dpp v185, v4, v3 row_newbcast:1 row_mask:0xf bank_mask:0xf
    buffer_load_dwordx4 v185, s[40:43], 0 offen lds
    s_add_u32 m0, s73, 0
    v_add_u32_dpp v185, v4, v3 row_newbcast:2 row_mask:0xf bank_mask:0xf
    buffer_load_dwordx4 v185, s[40:43], 0 offen lds
    s_add_u32 m0, s73, 1024
    v_add_u32_dpp v185, v4, v3 row_newbcast:3 row_mask:0xf bank_mask:0xf
    buffer_load_dwordx4 v185, s[40:43], 0 offen lds
    s_add_u32 m0, s74, 0
    v_add_u32_dpp v185, v4, v3 row_newbcast:4 row_mask:0xf bank_mask:0xf
    buffer_load_dwordx4 v185, s[40:43], 0 offen lds
    s_waitcnt vmcnt(5)
    s_barrier
    s_cmp_eq_u32 s59, 0
    s_cbranch_scc1 L2_drain
    v_lshlrev_b32_sdwa v186, 4, v5 dst_sel:DWORD dst_unused:UNUSED_PAD src0_sel:DWORD src1_sel:WORD_0
    s_mov_b64 exec, s[64:65]
    ds_read_b128 v[92:95], v186
    s_mov_b64 exec, s[66:67]
    ds_read_b128 v[96:99], v186
    s_mov_b64 exec, -1
    s_waitcnt lgkmcnt(0)
    v_mfma_f32_32x32x16_bf16 v[196:211], v[92:95], v[76:79], 0
    v_mfma_f32_32x32x16_bf16 v[196:211], v[96:99], v[80:83], v[196:211]
    v_add_u32_dpp v185, v4, v3 row_newbcast:5 row_mask:0xf bank_mask:0xf
    s_add_u32 m0, s74, 1024
L2_loop:
    s_waitcnt vmcnt(4) lgkmcnt(0)
    buffer_load_dwordx4 v185, s[40:43], 0 offen lds
    ds_read_b64_tr_b16 v[240:241], v182 offset:0
    ds_read_b64_tr_b16 v[242:243], v182 offset:512
    s_set_gpr_idx_on s70, gpr_idx(SRC2,DST)
    v_pk_fma_f32 v[8:9], v[188:189], v[218:219], v[8:9] op_sel_hi:[1,0,1]
    v_pk_fma_f32 v[10:11], v[190:191], v[218:219], v[10:11] op_sel_hi:[1,0,1]
    s_set_gpr_idx_idx s71
    v_pk_fma_f32 v[8:9], v[192:193], v[226:227], v[8:9] op_sel_hi:[1,0,1]
    v_pk_fma_f32 v[10:11], v[194:195], v[226:227], v[10:11] op_sel_hi:[1,0,1]
    s_add_u32 m0, s72, 0
    s_lshr_b64 s[70:71], s[70:71], 8
    v_mfma_f32_4x4x4_16b_bf16 v[188:191], v[230:231], v[244:245], 0 cbsz:4 abid:7
    v_mfma_f32_4x4x4_16b_bf16 v[192:195], v[230:231], v[246:247], 0 cbsz:4 abid:15
    v_add_u32_dpp v185, v4, v3 row_newbcast:6 row_mask:0xf bank_mask:0xf
    s_waitcnt vmcnt(4) lgkmcnt(0)
    buffer_load_dwordx4 v185, s[40:43], 0 offen lds
    ds_read_b64_tr_b16 v[244:245], v182 offset:1024
    ds_read_b64_tr_b16 v[246:247], v182 offset:1536
    s_set_gpr_idx_on s70, gpr_idx(SRC2,DST)
    v_pk_fma_f32 v[8:9], v[188:189], v[218:219], v[8:9] op_sel:[0,1,0] op_sel_hi:[1,1,1]
    v_pk_fma_f32 v[10:11], v[190:191], v[218:219], v[10:11] op_sel:[0,1,0] op_sel_hi:[1,1,1]
    s_set_gpr_idx_idx s71
    v_pk_fma_f32 v[8:9], v[192:193], v[226:227], v[8:9] op_sel:[0,1,0] op_sel_hi:[1,1,1]
    v_pk_fma_f32 v[10:11], v[194:195], v[226:227], v[10:11] op_sel:[0,1,0] op_sel_hi:[1,1,1]
    s_add_u32 m0, s72, 1024
    s_nop 0
    v_mfma_f32_4x4x4_16b_bf16 v[188:191], v[228:229], v[240:241], 0 cbsz:4 abid:0
    v_mfma_f32_4x4x4_16b_bf16 v[192:195], v[228:229], v[242:243], 0 cbsz:4 abid:8
    v_add_u32_dpp v185, v4, v3 row_newbcast:7 row_mask:0xf bank_mask:0xf
    v_mov_b64 v[230:231], v[232:233]
    v_readlane_b32 s70, v237, s61
    v_readlane_b32 s71, v239, s61
    s_add_u32 s61, s61, 1
    s_waitcnt vmcnt(4) lgkmcnt(0)
    buffer_load_dwordx4 v185, s[40:43], 0 offen lds
    ds_read_b64_tr_b16 v[240:241], v183 offset:0
    ds_read_b64_tr_b16 v[242:243], v183 offset:512
    s_set_gpr_idx_on s68, gpr_idx(SRC2,DST)
    v_pk_fma_f32 v[8:9], v[188:189], v[196:197], v[8:9] op_sel_hi:[1,0,1]
    v_pk_fma_f32 v[10:11], v[190:191], v[196:197], v[10:11] op_sel_hi:[1,0,1]
    s_set_gpr_idx_idx s69
    v_pk_fma_f32 v[8:9], v[192:193], v[204:205], v[8:9] op_sel_hi:[1,0,1]
    v_pk_fma_f32 v[10:11], v[194:195], v[204:205], v[10:11] op_sel_hi:[1,0,1]
    s_add_u32 m0, s73, 0
    s_lshr_b64 s[68:69], s[68:69], 8
    v_mfma_f32_4x4x4_16b_bf16 v[188:191], v[228:229], v[244:245], 0 cbsz:4 abid:1
    v_mfma_f32_4x4x4_16b_bf16 v[192:195], v[228:229], v[246:247], 0 cbsz:4 abid:9
    v_add_u32_dpp v185, v4, v3 row_newbcast:8 row_mask:0xf bank_mask:0xf
    s_waitcnt vmcnt(4) lgkmcnt(0)
    buffer_load_dwordx4 v185, s[40:43], 0 offen lds
    ds_read_b64_tr_b16 v[244:245], v183 offset:1024
    ds_read_b64_tr_b16 v[246:247], v183 offset:1536
    v_lshlrev_b32_sdwa v186, 4, v5 dst_sel:DWORD dst_unused:UNUSED_PAD src0_sel:DWORD src1_sel:WORD_1
    s_mov_b64 exec, s[64:65]
    ds_read_b128 v[92:95], v186
    s_mov_b64 exec, s[66:67]
    ds_read_b128 v[96:99], v186
    s_mov_b64 exec, -1
    s_set_gpr_idx_on s68, gpr_idx(SRC2,DST)
    v_pk_fma_f32 v[8:9], v[188:189], v[196:197], v[8:9] op_sel:[0,1,0] op_sel_hi:[1,1,1]
    v_pk_fma_f32 v[10:11], v[190:191], v[196:197], v[10:11] op_sel:[0,1,0] op_sel_hi:[1,1,1]
    s_set_gpr_idx_idx s69
    v_pk_fma_f32 v[8:9], v[192:193], v[204:205], v[8:9] op_sel:[0,1,0] op_sel_hi:[1,1,1]
    v_pk_fma_f32 v[10:11], v[194:195], v[204:205], v[10:11] op_sel:[0,1,0] op_sel_hi:[1,1,1]
    s_add_u32 m0, s73, 1024
    s_lshr_b64 s[68:69], s[68:69], 8
    v_mfma_f32_4x4x4_16b_bf16 v[188:191], v[228:229], v[240:241], 0 cbsz:4 abid:2
    v_mfma_f32_4x4x4_16b_bf16 v[192:195], v[228:229], v[242:243], 0 cbsz:4 abid:10
    v_add_u32_dpp v185, v4, v3 row_newbcast:9 row_mask:0xf bank_mask:0xf
    s_waitcnt vmcnt(4) lgkmcnt(0)
    buffer_load_dwordx4 v185, s[40:43], 0 offen lds
    ds_read_b64_tr_b16 v[240:241], v184 offset:0
    ds_read_b64_tr_b16 v[242:243], v184 offset:512
    s_set_gpr_idx_on s68, gpr_idx(SRC2,DST)
    v_pk_fma_f32 v[8:9], v[188:189], v[198:199], v[8:9] op_sel_hi:[1,0,1]
    v_pk_fma_f32 v[10:11], v[190:191], v[198:199], v[10:11] op_sel_hi:[1,0,1]
    s_set_gpr_idx_idx s69
    v_pk_fma_f32 v[8:9], v[192:193], v[206:207], v[8:9] op_sel_hi:[1,0,1]
    v_pk_fma_f32 v[10:11], v[194:195], v[206:207], v[10:11] op_sel_hi:[1,0,1]
    s_add_u32 m0, s74, 0
    s_lshr_b64 s[68:69], s[68:69], 8
    v_mfma_f32_4x4x4_16b_bf16 v[188:191], v[228:229], v[244:245], 0 cbsz:4 abid:3
    v_mfma_f32_4x4x4_16b_bf16 v[192:195], v[228:229], v[246:247], 0 cbsz:4 abid:11
    v_add_u32_dpp v185, v4, v3 row_newbcast:10 row_mask:0xf bank_mask:0xf
    v_mfma_f32_32x32x16_bf16 v[212:227], v[92:95], v[76:79], 0
    v_mfma_f32_32x32x16_bf16 v[212:227], v[96:99], v[80:83], v[212:227]
    s_waitcnt vmcnt(4) lgkmcnt(0)
    buffer_load_dwordx4 v185, s[40:43], 0 offen lds
    ds_read_b64_tr_b16 v[244:245], v184 offset:1024
    ds_read_b64_tr_b16 v[246:247], v184 offset:1536
    s_set_gpr_idx_on s68, gpr_idx(SRC2,DST)
    v_pk_fma_f32 v[8:9], v[188:189], v[198:199], v[8:9] op_sel:[0,1,0] op_sel_hi:[1,1,1]
    v_pk_fma_f32 v[10:11], v[190:191], v[198:199], v[10:11] op_sel:[0,1,0] op_sel_hi:[1,1,1]
    s_set_gpr_idx_idx s69
    v_pk_fma_f32 v[8:9], v[192:193], v[206:207], v[8:9] op_sel:[0,1,0] op_sel_hi:[1,1,1]
    v_pk_fma_f32 v[10:11], v[194:195], v[206:207], v[10:11] op_sel:[0,1,0] op_sel_hi:[1,1,1]
    s_add_u32 m0, s74, 1024
    s_nop 0
    v_mfma_f32_4x4x4_16b_bf16 v[188:191], v[228:229], v[240:241], 0 cbsz:4 abid:4
    v_mfma_f32_4x4x4_16b_bf16 v[192:195], v[228:229], v[242:243], 0 cbsz:4 abid:12
    v_add_u32_dpp v185, v4, v3 row_newbcast:11 row_mask:0xf bank_mask:0xf
    s_cmp_lt_u32 s27, 4
    s_cbranch_scc1 L2_prio
    s_setprio 1
L2_prio:
    s_waitcnt vmcnt(4) lgkmcnt(0)
    buffer_load_dwordx4 v185, s[40:43], 0 offen lds
    ds_read_b64_tr_b16 v[240:241], v182 offset:0
    ds_read_b64_tr_b16 v[242:243], v182 offset:512
    s_set_gpr_idx_on s70, gpr_idx(SRC2,DST)
    v_pk_fma_f32 v[8:9], v[188:189], v[200:201], v[8:9] op_sel_hi:[1,0,1]
    v_pk_fma_f32 v[10:11], v[190:191], v[200:201], v[10:11] op_sel_hi:[1,0,1]
    s_set_gpr_idx_idx s71
    v_pk_fma_f32 v[8:9], v[192:193], v[208:209], v[8:9] op_sel_hi:[1,0,1]
    v_pk_fma_f32 v[10:11], v[194:195], v[208:209], v[10:11] op_sel_hi:[1,0,1]
    s_add_u32 m0, s72, 0
    s_lshr_b64 s[70:71], s[70:71], 8
    v_mfma_f32_4x4x4_16b_bf16 v[188:191], v[228:229], v[244:245], 0 cbsz:4 abid:5
    v_mfma_f32_4x4x4_16b_bf16 v[192:195], v[228:229], v[246:247], 0 cbsz:4 abid:13
    v_add_u32_dpp v185, v4, v3 row_newbcast:12 row_mask:0xf bank_mask:0xf
    v_readlane_b32 s68, v236, s61
    v_readlane_b32 s69, v238, s61
    s_waitcnt vmcnt(4) lgkmcnt(0)
    buffer_load_dwordx4 v185, s[40:43], 0 offen lds
    ds_read_b64_tr_b16 v[244:245], v182 offset:1024
    ds_read_b64_tr_b16 v[246:247], v182 offset:1536
    s_set_gpr_idx_on s70, gpr_idx(SRC2,DST)
    v_pk_fma_f32 v[8:9], v[188:189], v[200:201], v[8:9] op_sel:[0,1,0] op_sel_hi:[1,1,1]
    v_pk_fma_f32 v[10:11], v[190:191], v[200:201], v[10:11] op_sel:[0,1,0] op_sel_hi:[1,1,1]
    s_set_gpr_idx_idx s71
    v_pk_fma_f32 v[8:9], v[192:193], v[208:209], v[8:9] op_sel:[0,1,0] op_sel_hi:[1,1,1]
    v_pk_fma_f32 v[10:11], v[194:195], v[208:209], v[10:11] op_sel:[0,1,0] op_sel_hi:[1,1,1]
    s_add_u32 m0, s72, 1024
    s_lshr_b64 s[70:71], s[70:71], 8
    v_mfma_f32_4x4x4_16b_bf16 v[188:191], v[228:229], v[240:241], 0 cbsz:4 abid:6
    v_mfma_f32_4x4x4_16b_bf16 v[192:195], v[228:229], v[242:243], 0 cbsz:4 abid:14
    v_add_u32_dpp v185, v4, v3 row_newbcast:13 row_mask:0xf bank_mask:0xf
    s_cmp_le_i32 s61, s82
    s_cbranch_scc1 L2_ev0
L2_evdone0:
    s_cmp_lt_u32 s61, s59
    s_cbranch_scc0 L2_tail0
    s_waitcnt vmcnt(4) lgkmcnt(0)
    buffer_load_dwordx4 v185, s[40:43], 0 offen lds
    ds_read_b64_tr_b16 v[240:241], v183 offset:0
    ds_read_b64_tr_b16 v[242:243], v183 offset:512
    s_set_gpr_idx_on s70, gpr_idx(SRC2,DST)
    v_pk_fma_f32 v[8:9], v[188:189], v[202:203], v[8:9] op_sel_hi:[1,0,1]
    v_pk_fma_f32 v[10:11], v[190:191], v[202:203], v[10:11] op_sel_hi:[1,0,1]
    s_set_gpr_idx_idx s71
    v_pk_fma_f32 v[8:9], v[192:193], v[210:211], v[8:9] op_sel_hi:[1,0,1]
    v_pk_fma_f32 v[10:11], v[194:195], v[210:211], v[10:11] op_sel_hi:[1,0,1]
    s_add_u32 m0, s73, 0
    s_lshr_b64 s[70:71], s[70:71], 8
    v_mfma_f32_4x4x4_16b_bf16 v[188:191], v[228:229], v[244:245], 0 cbsz:4 abid:7
    v_mfma_f32_4x4x4_16b_bf16 v[192:195], v[228:229], v[246:247], 0 cbsz:4 abid:15
    v_add_u32_dpp v185, v4, v3 row_newbcast:14 row_mask:0xf bank_mask:0xf
    s_waitcnt vmcnt(4) lgkmcnt(0)
    buffer_load_dwordx4 v185, s[40:43], 0 offen lds
    ds_read_b64_tr_b16 v[244:245], v183 offset:1024
    ds_read_b64_tr_b16 v[246:247], v183 offset:1536
    s_set_gpr_idx_on s70, gpr_idx(SRC2,DST)
    v_pk_fma_f32 v[8:9], v[188:189], v[202:203], v[8:9] op_sel:[0,1,0] op_sel_hi:[1,1,1]
    v_pk_fma_f32 v[10:11], v[190:191], v[202:203], v[10:11] op_sel:[0,1,0] op_sel_hi:[1,1,1]
    s_set_gpr_idx_idx s71
    v_pk_fma_f32 v[8:9], v[192:193], v[210:211], v[8:9] op_sel:[0,1,0] op_sel_hi:[1,1,1]
    v_pk_fma_f32 v[10:11], v[194:195], v[210:211], v[10:11] op_sel:[0,1,0] op_sel_hi:[1,1,1]
    s_add_u32 m0, s73, 1024
    s_add_u32 s77, s77, 1
    v_mfma_f32_4x4x4_16b_bf16 v[188:191], v[230:231], v[240:241], 0 cbsz:4 abid:0
    v_mfma_f32_4x4x4_16b_bf16 v[192:195], v[230:231], v[242:243], 0 cbsz:4 abid:8
    v_add_u32_dpp v185, v4, v3 row_newbcast:15 row_mask:0xf bank_mask:0xf
    v_readlane_b32 s70, v237, s61
    v_readlane_b32 s71, v239, s61
    s_add_u32 s61, s61, 1
    s_and_b32 s78, s77, 0xfe
    s_and_b32 s76, s61, 2
    s_waitcnt vmcnt(4) lgkmcnt(0)
    buffer_load_dwordx4 v185, s[40:43], 0 offen lds
    ds_read_b64_tr_b16 v[240:241], v184 offset:0
    ds_read_b64_tr_b16 v[242:243], v184 offset:512
    s_set_gpr_idx_on s68, gpr_idx(SRC2,DST)
    v_pk_fma_f32 v[8:9], v[188:189], v[212:213], v[8:9] op_sel_hi:[1,0,1]
    v_pk_fma_f32 v[10:11], v[190:191], v[212:213], v[10:11] op_sel_hi:[1,0,1]
    s_set_gpr_idx_idx s69
    v_pk_fma_f32 v[8:9], v[192:193], v[220:221], v[8:9] op_sel_hi:[1,0,1]
    v_pk_fma_f32 v[10:11], v[194:195], v[220:221], v[10:11] op_sel_hi:[1,0,1]
    s_set_gpr_idx_on s77, gpr_idx(SRC0)
    v_mov_b32 v4, v132
    v_mov_b32 v5, v164
    s_set_gpr_idx_idx s78
    v_mfma_f32_4x4x4_16b_bf16 v[196:199], v[148:149], v[84:85], 0
    v_mfma_f32_4x4x4_16b_bf16 v[200:203], v[148:149], v[86:87], 0
    v_mfma_f32_4x4x4_16b_bf16 v[204:207], v[148:149], v[88:89], 0
    v_mfma_f32_4x4x4_16b_bf16 v[208:211], v[148:149], v[90:91], 0
    s_add_u32 m0, s74, 0
    s_lshr_b64 s[68:69], s[68:69], 8
    v_mfma_f32_4x4x4_16b_bf16 v[188:191], v[230:231], v[244:245], 0 cbsz:4 abid:1
    v_mfma_f32_4x4x4_16b_bf16 v[192:195], v[230:231], v[246:247], 0 cbsz:4 abid:9
    v_add_u32_dpp v185, v4, v3 row_newbcast:0 row_mask:0xf bank_mask:0xf
    s_waitcnt vmcnt(4) lgkmcnt(0)
    buffer_load_dwordx4 v185, s[40:43], 0 offen lds
    ds_read_b64_tr_b16 v[244:245], v184 offset:1024
    ds_read_b64_tr_b16 v[246:247], v184 offset:1536
    v_lshlrev_b32_sdwa v186, 4, v5 dst_sel:DWORD dst_unused:UNUSED_PAD src0_sel:DWORD src1_sel:WORD_0
    s_mov_b64 exec, s[64:65]
    ds_read_b128 v[92:95], v186
    s_mov_b64 exec, s[66:67]
    ds_read_b128 v[96:99], v186
    s_mov_b64 exec, -1
    s_set_gpr_idx_on s68, gpr_idx(SRC2,DST)
    v_pk_fma_f32 v[8:9], v[188:189], v[212:213], v[8:9] op_sel:[0,1,0] op_sel_hi:[1,1,1]
    v_pk_fma_f32 v[10:11], v[190:191], v[212:213], v[10:11] op_sel:[0,1,0] op_sel_hi:[1,1,1]
    s_set_gpr_idx_idx s69
    v_pk_fma_f32 v[8:9], v[192:193], v[220:221], v[8:9] op_sel:[0,1,0] op_sel_hi:[1,1,1]
    v_pk_fma_f32 v[10:11], v[194:195], v[220:221], v[10:11] op_sel:[0,1,0] op_sel_hi:[1,1,1]
    s_set_gpr_idx_on s76, gpr_idx(SRC0,SRC1)
    v_cvt_pk_bf16_f32 v228, v196, v200
    v_cvt_pk_bf16_f32 v229, v204, v208
    v_cvt_pk_bf16_f32 v232, v197, v201
    v_cvt_pk_bf16_f32 v233, v205, v209
    s_add_u32 m0, s74, 1024
    s_lshr_b64 s[68:69], s[68:69], 8
    v_mfma_f32_4x4x4_16b_bf16 v[188:191], v[230:231], v[240:241], 0 cbsz:4 abid:2
    v_mfma_f32_4x4x4_16b_bf16 v[192:195], v[230:231], v[242:243], 0 cbsz:4 abid:10
    v_add_u32_dpp v185, v4, v3 row_newbcast:1 row_mask:0xf bank_mask:0xf
    s_waitcnt vmcnt(4) lgkmcnt(0)
    buffer_load_dwordx4 v185, s[40:43], 0 offen lds
    ds_read_b64_tr_b16 v[240:241], v182 offset:0
    ds_read_b64_tr_b16 v[242:243], v182 offset:512
    s_set_gpr_idx_on s68, gpr_idx(SRC2,DST)
    v_pk_fma_f32 v[8:9], v[188:189], v[214:215], v[8:9] op_sel_hi:[1,0,1]
    v_pk_fma_f32 v[10:11], v[190:191], v[214:215], v[10:11] op_sel_hi:[1,0,1]
    s_set_gpr_idx_idx s69
    v_pk_fma_f32 v[8:9], v[192:193], v[222:223], v[8:9] op_sel_hi:[1,0,1]
    v_pk_fma_f32 v[10:11], v[194:195], v[222:223], v[10:11] op_sel_hi:[1,0,1]
    s_add_u32 m0, s72, 0
    s_lshr_b64 s[68:69], s[68:69], 8
    v_mfma_f32_4x4x4_16b_bf16 v[188:191], v[230:231], v[244:245], 0 cbsz:4 abid:3
    v_mfma_f32_4x4x4_16b_bf16 v[192:195], v[230:231], v[246:247], 0 cbsz:4 abid:11
    v_add_u32_dpp v185, v4, v3 row_newbcast:2 row_mask:0xf bank_mask:0xf
    v_mfma_f32_32x32x16_bf16 v[196:211], v[92:95], v[76:79], 0
    v_mfma_f32_32x32x16_bf16 v[196:211], v[96:99], v[80:83], v[196:211]
    s_waitcnt vmcnt(4) lgkmcnt(0)
    buffer_load_dwordx4 v185, s[40:43], 0 offen lds
    ds_read_b64_tr_b16 v[244:245], v182 offset:1024
    ds_read_b64_tr_b16 v[246:247], v182 offset:1536
    s_set_gpr_idx_on s68, gpr_idx(SRC2,DST)
    v_pk_fma_f32 v[8:9], v[188:189], v[214:215], v[8:9] op_sel:[0,1,0] op_sel_hi:[1,1,1]
    v_pk_fma_f32 v[10:11], v[190:191], v[214:215], v[10:11] op_sel:[0,1,0] op_sel_hi:[1,1,1]
    s_set_gpr_idx_idx s69
    v_pk_fma_f32 v[8:9], v[192:193], v[222:223], v[8:9] op_sel:[0,1,0] op_sel_hi:[1,1,1]
    v_pk_fma_f32 v[10:11], v[194:195], v[222:223], v[10:11] op_sel:[0,1,0] op_sel_hi:[1,1,1]
    s_add_u32 m0, s72, 1024
    s_setprio 0
    v_mfma_f32_4x4x4_16b_bf16 v[188:191], v[230:231], v[240:241], 0 cbsz:4 abid:4
    v_mfma_f32_4x4x4_16b_bf16 v[192:195], v[230:231], v[242:243], 0 cbsz:4 abid:12
    v_add_u32_dpp v185, v4, v3 row_newbcast:3 row_mask:0xf bank_mask:0xf
    s_waitcnt vmcnt(4) lgkmcnt(0)
    buffer_load_dwordx4 v185, s[40:43], 0 offen lds
    ds_read_b64_tr_b16 v[240:241], v183 offset:0
    ds_read_b64_tr_b16 v[242:243], v183 offset:512
    s_set_gpr_idx_on s70, gpr_idx(SRC2,DST)
    v_pk_fma_f32 v[8:9], v[188:189], v[216:217], v[8:9] op_sel_hi:[1,0,1]
    v_pk_fma_f32 v[10:11], v[190:191], v[216:217], v[10:11] op_sel_hi:[1,0,1]
    s_set_gpr_idx_idx s71
    v_pk_fma_f32 v[8:9], v[192:193], v[224:225], v[8:9] op_sel_hi:[1,0,1]
    v_pk_fma_f32 v[10:11], v[194:195], v[224:225], v[10:11] op_sel_hi:[1,0,1]
    s_add_u32 m0, s73, 0
    s_lshr_b64 s[70:71], s[70:71], 8
    v_mfma_f32_4x4x4_16b_bf16 v[188:191], v[230:231], v[244:245], 0 cbsz:4 abid:5
    v_mfma_f32_4x4x4_16b_bf16 v[192:195], v[230:231], v[246:247], 0 cbsz:4 abid:13
    v_add_u32_dpp v185, v4, v3 row_newbcast:4 row_mask:0xf bank_mask:0xf
    v_readlane_b32 s68, v236, s61
    v_readlane_b32 s69, v238, s61
    s_waitcnt vmcnt(4) lgkmcnt(0)
    buffer_load_dwordx4 v185, s[40:43], 0 offen lds
    ds_read_b64_tr_b16 v[244:245], v183 offset:1024
    ds_read_b64_tr_b16 v[246:247], v183 offset:1536
    s_set_gpr_idx_on s70, gpr_idx(SRC2,DST)
    v_pk_fma_f32 v[8:9], v[188:189], v[216:217], v[8:9] op_sel:[0,1,0] op_sel_hi:[1,1,1]
    v_pk_fma_f32 v[10:11], v[190:191], v[216:217], v[10:11] op_sel:[0,1,0] op_sel_hi:[1,1,1]
    s_set_gpr_idx_idx s71
    v_pk_fma_f32 v[8:9], v[192:193], v[224:225], v[8:9] op_sel:[0,1,0] op_sel_hi:[1,1,1]
    v_pk_fma_f32 v[10:11], v[194:195], v[224:225], v[10:11] op_sel:[0,1,0] op_sel_hi:[1,1,1]
    s_add_u32 m0, s73, 1024
    s_lshr_b64 s[70:71], s[70:71], 8
    v_mfma_f32_4x4x4_16b_bf16 v[188:191], v[230:231], v[240:241], 0 cbsz:4 abid:6
    v_mfma_f32_4x4x4_16b_bf16 v[192:195], v[230:231], v[242:243], 0 cbsz:4 abid:14
    v_add_u32_dpp v185, v4, v3 row_newbcast:5 row_mask:0xf bank_mask:0xf
    v_swap_b32 v182, v184
    v_swap_b32 v183, v184
    s_mov_b32 s75, s74
    s_mov_b32 s74, s73
    s_mov_b32 s73, s72
    s_mov_b32 s72, s75
    s_cmp_le_i32 s61, s82
    s_cbranch_scc1 L2_ev1
L2_evdone1:
    s_cmp_lt_u32 s61, s59
    s_cbranch_scc1 L2_loop
    s_waitcnt lgkmcnt(0)
    s_set_gpr_idx_on s70, gpr_idx(SRC2,DST)
    v_pk_fma_f32 v[8:9], v[188:189], v[218:219], v[8:9] op_sel_hi:[1,0,1]
    v_pk_fma_f32 v[10:11], v[190:191], v[218:219], v[10:11] op_sel_hi:[1,0,1]
    s_set_gpr_idx_idx s71
    v_pk_fma_f32 v[8:9], v[192:193], v[226:227], v[8:9] op_sel_hi:[1,0,1]
    v_pk_fma_f32 v[10:11], v[194:195], v[226:227], v[10:11] op_sel_hi:[1,0,1]
    s_set_gpr_idx_off
    s_lshr_b64 s[70:71], s[70:71], 8
    v_mfma_f32_4x4x4_16b_bf16 v[188:191], v[230:231], v[244:245], 0 cbsz:4 abid:7
    v_mfma_f32_4x4x4_16b_bf16 v[192:195], v[230:231], v[246:247], 0 cbsz:4 abid:15
    s_nop 4
    s_set_gpr_idx_on s70, gpr_idx(SRC2,DST)
    v_pk_fma_f32 v[8:9], v[188:189], v[218:219], v[8:9] op_sel:[0,1,0] op_sel_hi:[1,1,1]
    v_pk_fma_f32 v[10:11], v[190:191], v[218:219], v[10:11] op_sel:[0,1,0] op_sel_hi:[1,1,1]
    s_set_gpr_idx_idx s71
    v_pk_fma_f32 v[8:9], v[192:193], v[226:227], v[8:9] op_sel:[0,1,0] op_sel_hi:[1,1,1]
    v_pk_fma_f32 v[10:11], v[194:195], v[226:227], v[10:11] op_sel:[0,1,0] op_sel_hi:[1,1,1]
    s_set_gpr_idx_off
    s_branch L2_drain
L2_tail0:
    s_waitcnt lgkmcnt(0)
    s_set_gpr_idx_on s70, gpr_idx(SRC2,DST)
    v_pk_fma_f32 v[8:9], v[188:189], v[202:203], v[8:9] op_sel_hi:[1,0,1]
    v_pk_fma_f32 v[10:11], v[190:191], v[202:203], v[10:11] op_sel_hi:[1,0,1]
    s_set_gpr_idx_idx s71
    v_pk_fma_f32 v[8:9], v[192:193], v[210:211], v[8:9] op_sel_hi:[1,0,1]
    v_pk_fma_f32 v[10:11], v[194:195], v[210:211], v[10:11] op_sel_hi:[1,0,1]
    s_set_gpr_idx_off
    s_lshr_b64 s[70:71], s[70:71], 8
    v_mfma_f32_4x4x4_16b_bf16 v[188:191], v[228:229], v[244:245], 0 cbsz:4 abid:7
    v_mfma_f32_4x4x4_16b_bf16 v[192:195], v[228:229], v[246:247], 0 cbsz:4 abid:15
    s_nop 4
    s_set_gpr_idx_on s70, gpr_idx(SRC2,DST)
    v_pk_fma_f32 v[8:9], v[188:189], v[202:203], v[8:9] op_sel:[0,1,0] op_sel_hi:[1,1,1]
    v_pk_fma_f32 v[10:11], v[190:191], v[202:203], v[10:11] op_sel:[0,1,0] op_sel_hi:[1,1,1]
    s_set_gpr_idx_idx s71
    v_pk_fma_f32 v[8:9], v[192:193], v[210:211], v[8:9] op_sel:[0,1,0] op_sel_hi:[1,1,1]
    v_pk_fma_f32 v[10:11], v[194:195], v[210:211], v[10:11] op_sel:[0,1,0] op_sel_hi:[1,1,1]
    s_set_gpr_idx_off
    s_branch L2_drain
L2_ev0:
    s_cmp_lg_u32 s61, s82
    s_cbranch_scc1 L2_late0
    s_barrier
    s_branch L2_evdone0
L2_late0:
    s_mov_b32 s1, m0
    s_cmp_ge_u32 s80, s81
    s_cbranch_scc1 L2_nolate0
    s_set_gpr_idx_on s80, gpr_idx(SRC0)
    v_mov_b32 v186, v242
    s_lshl_b32 m0, s80, 13
    s_add_u32 m0, m0, s83
    s_add_u32 s80, s80, 1
    buffer_load_dwordx4 v186, s[32:35], 0 offen sc1 lds
L2_nolate0:
    s_mov_b32 m0, s1
    s_branch L2_evdone0
L2_ev1:
    s_cmp_lg_u32 s61, s82
    s_cbranch_scc1 L2_late1
    s_barrier
    s_branch L2_evdone1
L2_late1:
    s_mov_b32 s1, m0
    s_cmp_ge_u32 s80, s81
    s_cbranch_scc1 L2_nolate1
    s_set_gpr_idx_on s80, gpr_idx(SRC0)
    v_mov_b32 v186, v242
    s_lshl_b32 m0, s80, 13
    s_add_u32 m0, m0, s83
    s_add_u32 s80, s80, 1
    buffer_load_dwordx4 v186, s[32:35], 0 offen sc1 lds
L2_nolate1:
    s_mov_b32 m0, s1
    s_branch L2_evdone1
L2_drain:
    s_waitcnt vmcnt(0) lgkmcnt(0)
    s_add_u32 s57, s57, s62
    s_cmp_ge_u32 s57, s56
    s_cbranch_scc1 L2_epi
L2_again:
    s_barrier
    v_mov_b32 v200, 0x7fff
    v_mov_b32 v201, 0x7fff
    v_mov_b32 v202, 0x7fff
    v_mov_b32 v203, 0x7fff
    v_lshlrev_b32 v196, 4, v0
    v_add_u32 v196, 141760, v196
    ds_write_b128 v196, v[200:203]
    v_cmp_gt_u32 vcc, 398, v0
    s_and_b64 exec, exec, vcc
    ds_write_b128 v196, v[200:203] offset:8192
    s_mov_b64 exec, -1
    v_mov_b32 v204, 0x40404040
    v_cmp_gt_u32 vcc, 228, v0
    v_add_u32 v196, 14560, v196
    s_nop 0
    v_cndmask_b32 v204, 0, v204, vcc
    v_mov_b32 v205, v204
    v_mov_b32 v206, v204
    v_mov_b32 v207, v204
    v_cmp_gt_u32 vcc, 324, v0
    s_and_b64 exec, exec, vcc
    ds_write_b128 v196, v[204:207]
    s_mov_b64 exec, -1
    s_branch L2_round
L2_epi:
    s_sub_u32 s0, s86, 1
    s_and_b32 s0, s0, 15
    s_lshl_b32 s0, s0, 2
    s_and_b32 s69, s0, 32
    s_xor_b32 s68, s69, 32
    s_set_gpr_idx_on s68, gpr_idx(SRC0,SRC1)
    v_cvt_pk_bf16_f32 v76, v8, v9
    v_cvt_pk_bf16_f32 v77, v10, v11
    v_cvt_pk_bf16_f32 v78, v12, v13
    v_cvt_pk_bf16_f32 v79, v14, v15
    ds_write_b128 v180, v[76:79] offset:0
    v_cvt_pk_bf16_f32 v80, v16, v17
    v_cvt_pk_bf16_f32 v81, v18, v19
    v_cvt_pk_bf16_f32 v82, v20, v21
    v_cvt_pk_bf16_f32 v83, v22, v23
    ds_write_b128 v180, v[80:83] offset:16
    v_cvt_pk_bf16_f32 v84, v24, v25
    v_cvt_pk_bf16_f32 v85, v26, v27
    v_cvt_pk_bf16_f32 v86, v28, v29
    v_cvt_pk_bf16_f32 v87, v30, v31
    ds_write_b128 v180, v[84:87] offset:32
    v_cvt_pk_bf16_f32 v88, v32, v33
    v_cvt_pk_bf16_f32 v89, v34, v35
    v_cvt_pk_bf16_f32 v90, v36, v37
    v_cvt_pk_bf16_f32 v91, v38, v39
    ds_write_b128 v180, v[88:91] offset:48
    ds_read_b64_tr_b16 v[132:133], v181 offset:0
    ds_read_b64_tr_b16 v[134:135], v181 offset:320
    ds_read_b64_tr_b16 v[136:137], v181 offset:1280
    ds_read_b64_tr_b16 v[138:139], v181 offset:1600
    ds_read_b64_tr_b16 v[140:141], v181 offset:2560
    ds_read_b64_tr_b16 v[142:143], v181 offset:2880
    ds_read_b64_tr_b16 v[144:145], v181 offset:3840
    ds_read_b64_tr_b16 v[146:147], v181 offset:4160
    s_sub_u32 s1, s85, 1
    s_and_b32 s1, s1, 15
    s_lshl_b32 s1, s1, 2
    s_set_gpr_idx_on s1, gpr_idx(SRC0)
    v_mov_b32 v92, v8
    v_mov_b32 v93, v9
    v_mov_b32 v94, v10
    v_mov_b32 v95, v11
    s_set_gpr_idx_off
    v_and_b32 v172, 63, v0
    v_lshl_add_u32 v172, v172, 4, s3
    ds_write_b128 v172, v[92:95] offset:5120
    s_cmp_eq_u32 s27, 7
    s_cselect_b32 s0, 64, s0
    s_mul_i32 s1, s26, 98
    s_sub_u32 s90, 25000, s1
    s_min_u32 s90, s90, s86
    s_sub_i32 s90, s90, s85
    s_max_i32 s90, s90, 0
    s_lshl_b32 s90, s90, 9
    s_add_u32 s1, s1, s85
    s_lshl_b32 s1, s1, 9
    s_waitcnt lgkmcnt(7)
    v_mfma_f32_32x32x16_bf16 v[184:199], v[132:135], v[100:103], 0
    v_mfma_f32_32x32x16_bf16 v[200:215], v[132:135], v[116:119], 0
    s_add_u32 s36, s20, s1
    s_addc_u32 s37, s21, 0
    s_mov_b32 s38, s90
    s_mov_b32 s39, 0x20000
    s_lshr_b32 s1, s68, 2
    s_sub_u32 s1, s1, s85
    s_waitcnt lgkmcnt(5)
    v_mfma_f32_32x32x16_bf16 v[184:199], v[136:139], v[104:107], v[184:199]
    v_bfe_u32 v173, v0, 5, 1
    v_add_u32 v173, s1, v173
    v_and_b32 v174, 31, v0
    v_lshlrev_b32 v174, 2, v174
    v_lshl_add_u32 v173, v173, 9, v174
    v_mfma_f32_32x32x16_bf16 v[200:215], v[136:139], v[120:123], v[200:215]
    s_waitcnt lgkmcnt(0)
    v_mfma_f32_32x32x16_bf16 v[184:199], v[140:143], v[108:111], v[184:199]
    v_add_u32 v164, 0, v173
    v_and_b32 v164, 0x1fff, v164
    v_add_u32 v165, 1024, v173
    v_and_b32 v165, 0x1fff, v165
    v_mfma_f32_32x32x16_bf16 v[200:215], v[140:143], v[124:127], v[200:215]
    v_add_u32 v166, 2048, v173
    v_and_b32 v166, 0x1fff, v166
    v_add_u32 v167, 3072, v173
    v_and_b32 v167, 0x1fff, v167
    v_mfma_f32_32x32x16_bf16 v[184:199], v[144:147], v[112:115], v[184:199]
    v_add_u32 v168, 4096, v173
    v_and_b32 v168, 0x1fff, v168
    v_add_u32 v169, 5120, v173
    v_and_b32 v169, 0x1fff, v169
    v_mfma_f32_32x32x16_bf16 v[200:215], v[144:147], v[128:131], v[200:215]
    v_add_u32 v170, 6144, v173
    v_and_b32 v170, 0x1fff, v170
    v_add_u32 v171, 7168, v173
    v_and_b32 v171, 0x1fff, v171
    s_nop 7
    v_cvt_pk_bf16_f32 v184, v184, v200
    buffer_store_dword v184, v164, s[36:39], 0 offen offset:0 sc1
    v_cvt_pk_bf16_f32 v185, v185, v201
    buffer_store_dword v185, v164, s[36:39], 0 offen offset:128 sc1
    v_cvt_pk_bf16_f32 v186, v186, v202
    buffer_store_dword v186, v164, s[36:39], 0 offen offset:256 sc1
    v_cvt_pk_bf16_f32 v187, v187, v203
    buffer_store_dword v187, v164, s[36:39], 0 offen offset:384 sc1
    v_cvt_pk_bf16_f32 v188, v188, v204
    buffer_store_dword v188, v165, s[36:39], 0 offen offset:0 sc1
    v_cvt_pk_bf16_f32 v189, v189, v205
    buffer_store_dword v189, v165, s[36:39], 0 offen offset:128 sc1
    v_cvt_pk_bf16_f32 v190, v190, v206
    buffer_store_dword v190, v165, s[36:39], 0 offen offset:256 sc1
    v_cvt_pk_bf16_f32 v191, v191, v207
    buffer_store_dword v191, v165, s[36:39], 0 offen offset:384 sc1
    v_cvt_pk_bf16_f32 v192, v192, v208
    buffer_store_dword v192, v166, s[36:39], 0 offen offset:0 sc1
    v_cvt_pk_bf16_f32 v193, v193, v209
    buffer_store_dword v193, v166, s[36:39], 0 offen offset:128 sc1
    v_cvt_pk_bf16_f32 v194, v194, v210
    buffer_store_dword v194, v166, s[36:39], 0 offen offset:256 sc1
    v_cvt_pk_bf16_f32 v195, v195, v211
    buffer_store_dword v195, v166, s[36:39], 0 offen offset:384 sc1
    v_cvt_pk_bf16_f32 v196, v196, v212
    buffer_store_dword v196, v167, s[36:39], 0 offen offset:0 sc1
    v_cvt_pk_bf16_f32 v197, v197, v213
    buffer_store_dword v197, v167, s[36:39], 0 offen offset:128 sc1
    v_cvt_pk_bf16_f32 v198, v198, v214
    buffer_store_dword v198, v167, s[36:39], 0 offen offset:256 sc1
    v_cvt_pk_bf16_f32 v199, v199, v215
    buffer_store_dword v199, v167, s[36:39], 0 offen offset:384 sc1
    s_barrier
    ds_read_b128 v[92:95], v172 offset:11264
    s_waitcnt lgkmcnt(0)
    s_set_gpr_idx_on s0, gpr_idx(SRC0,DST)
    v_add_f32 v8, v8, v92
    v_add_f32 v9, v9, v93
    v_add_f32 v10, v10, v94
    v_add_f32 v11, v11, v95
    s_set_gpr_idx_on s69, gpr_idx(SRC0,SRC1)
    v_cvt_pk_bf16_f32 v76, v8, v9
    v_cvt_pk_bf16_f32 v77, v10, v11
    v_cvt_pk_bf16_f32 v78, v12, v13
    v_cvt_pk_bf16_f32 v79, v14, v15
    ds_write_b128 v180, v[76:79] offset:0
    v_cvt_pk_bf16_f32 v80, v16, v17
    v_cvt_pk_bf16_f32 v81, v18, v19
    v_cvt_pk_bf16_f32 v82, v20, v21
    v_cvt_pk_bf16_f32 v83, v22, v23
    ds_write_b128 v180, v[80:83] offset:16
    v_cvt_pk_bf16_f32 v84, v24, v25
    v_cvt_pk_bf16_f32 v85, v26, v27
    v_cvt_pk_bf16_f32 v86, v28, v29
    v_cvt_pk_bf16_f32 v87, v30, v31
    ds_write_b128 v180, v[84:87] offset:32
    v_cvt_pk_bf16_f32 v88, v32, v33
    v_cvt_pk_bf16_f32 v89, v34, v35
    v_cvt_pk_bf16_f32 v90, v36, v37
    v_cvt_pk_bf16_f32 v91, v38, v39
    ds_write_b128 v180, v[88:91] offset:48
    s_set_gpr_idx_off
    ds_read_b64_tr_b16 v[148:149], v181 offset:0
    ds_read_b64_tr_b16 v[150:151], v181 offset:320
    ds_read_b64_tr_b16 v[152:153], v181 offset:1280
    ds_read_b64_tr_b16 v[154:155], v181 offset:1600
    ds_read_b64_tr_b16 v[156:157], v181 offset:2560
    ds_read_b64_tr_b16 v[158:159], v181 offset:2880
    ds_read_b64_tr_b16 v[160:161], v181 offset:3840
    ds_read_b64_tr_b16 v[162:163], v181 offset:4160
    s_waitcnt lgkmcnt(6)
    v_mfma_f32_32x32x16_bf16 v[216:231], v[148:151], v[100:103], 0
    v_mfma_f32_32x32x16_bf16 v[232:247], v[148:151], v[116:119], 0
    s_waitcnt lgkmcnt(4)
    v_mfma_f32_32x32x16_bf16 v[216:231], v[152:155], v[104:107], v[216:231]
    v_mfma_f32_32x32x16_bf16 v[232:247], v[152:155], v[120:123], v[232:247]
    s_waitcnt lgkmcnt(2)
    v_mfma_f32_32x32x16_bf16 v[216:231], v[156:159], v[108:111], v[216:231]
    v_mfma_f32_32x32x16_bf16 v[232:247], v[156:159], v[124:127], v[232:247]
    s_waitcnt lgkmcnt(0)
    v_mfma_f32_32x32x16_bf16 v[216:231], v[160:163], v[112:115], v[216:231]
    v_mfma_f32_32x32x16_bf16 v[232:247], v[160:163], v[128:131], v[232:247]
    s_nop 11
    v_cvt_pk_bf16_f32 v216, v216, v232
    buffer_store_dword v216, v168, s[36:39], 0 offen offset:0 sc1
    v_cvt_pk_bf16_f32 v217, v217, v233
    buffer_store_dword v217, v168, s[36:39], 0 offen offset:128 sc1
    v_cvt_pk_bf16_f32 v218, v218, v234
    buffer_store_dword v218, v168, s[36:39], 0 offen offset:256 sc1
    v_cvt_pk_bf16_f32 v219, v219, v235
    buffer_store_dword v219, v168, s[36:39], 0 offen offset:384 sc1
    v_cvt_pk_bf16_f32 v220, v220, v236
    buffer_store_dword v220, v169, s[36:39], 0 offen offset:0 sc1
    v_cvt_pk_bf16_f32 v221, v221, v237
    buffer_store_dword v221, v169, s[36:39], 0 offen offset:128 sc1
    v_cvt_pk_bf16_f32 v222, v222, v238
    buffer_store_dword v222, v169, s[36:39], 0 offen offset:256 sc1
    v_cvt_pk_bf16_f32 v223, v223, v239
    buffer_store_dword v223, v169, s[36:39], 0 offen offset:384 sc1
    v_cvt_pk_bf16_f32 v224, v224, v240
    buffer_store_dword v224, v170, s[36:39], 0 offen offset:0 sc1
    v_cvt_pk_bf16_f32 v225, v225, v241
    buffer_store_dword v225, v170, s[36:39], 0 offen offset:128 sc1
    v_cvt_pk_bf16_f32 v226, v226, v242
    buffer_store_dword v226, v170, s[36:39], 0 offen offset:256 sc1
    v_cvt_pk_bf16_f32 v227, v227, v243
    buffer_store_dword v227, v170, s[36:39], 0 offen offset:384 sc1
    v_cvt_pk_bf16_f32 v228, v228, v244
    buffer_store_dword v228, v171, s[36:39], 0 offen offset:0 sc1
    v_cvt_pk_bf16_f32 v229, v229, v245
    buffer_store_dword v229, v171, s[36:39], 0 offen offset:128 sc1
    v_cvt_pk_bf16_f32 v230, v230, v246
    buffer_store_dword v230, v171, s[36:39], 0 offen offset:256 sc1
    v_cvt_pk_bf16_f32 v231, v231, v247
    buffer_store_dword v231, v171, s[36:39], 0 offen offset:384 sc1
L2_end:
    s_endpgm
.section .rodata,"a"
.p2align 6
.amdhsa_kernel standalone__tensor_product_equiv_mace__graph_kernel
  .amdhsa_next_free_vgpr 256
  .amdhsa_next_free_sgpr 102
  .amdhsa_accum_offset 256
  .amdhsa_group_segment_fixed_size 0
  .amdhsa_kernarg_size 88
  .amdhsa_user_sgpr_count 2
  .amdhsa_user_sgpr_kernarg_segment_ptr 1
  .amdhsa_system_sgpr_workgroup_id_x 1
  .amdhsa_float_denorm_mode_32 3
.end_amdhsa_kernel
```
